```python
import torch

def _softmax(x, axis=-1):
    return torch.softmax(x, dim=axis)
def _gelu(x):
    return torch.nn.functional.gelu(x, approximate="tanh")
def _silu(x):
    return torch.nn.functional.silu(x)
def _sigmoid(x):
    return torch.sigmoid(x)
def _layernorm(x, axis=-1, eps=1e-5):
    m = x.mean(dim=axis, keepdim=True)
    v = x.var(dim=axis, keepdim=True, unbiased=False)
    return (x - m) / torch.sqrt(v + eps)
def _scatter_add(tgt, idx, src, axis=0):
    return tgt.clone().index_add_(axis, idx, src)
def _segment_sum(src, seg, n):
    out = torch.zeros((n,) + src.shape[1:], dtype=src.dtype)
    return out.index_add_(0, seg, src)
def _pad(x, pw):
    flat = tuple(v for pair in reversed(pw) for v in pair)
    return torch.nn.functional.pad(x, flat)

kernel_name = 'standalone__mha_block_cached__near_ridge'

def setup_inputs():

    _w = (lambda a: (lambda t: t.to(torch.bfloat16) if t.is_floating_point() else t)(torch.as_tensor(a)))
    B, Sq, D = 16, 128, 512
    H, Sk, Dh = 32, 512, 128
    return {
        "x": _w((lambda *s: torch.randn(*s, dtype=torch.bfloat16) * 0.8)(B, Sq, D)),
        "k_cache": _w((lambda *s: torch.randn(*s, dtype=torch.bfloat16) * 0.8)(B, H, Sk, Dh)),
        "v_cache": _w((lambda *s: torch.randn(*s, dtype=torch.bfloat16) * 0.05)(B, H, Sk, Dh)),
        "wq": _w((lambda *s: torch.randn(*s, dtype=torch.bfloat16) * 0.8)(D, H * Dh) * (D ** -0.5)),
        "wo": _w((lambda *s: torch.randn(*s, dtype=torch.bfloat16) * 0.05)(H * Dh, D) * ((H * Dh) ** -0.5)),
    }

def reference(x, k_cache, v_cache, wq, wo):
    B, Sq, D = x.shape
    H, Dh = 32, 128
    q = (lambda x, *d: x.permute(*d))((x @ wq).reshape(B, Sq, H, Dh), 0, 2, 1, 3)
    scores = torch.einsum("bhqd,bhkd->bhqk", q, k_cache) * (Dh ** -0.5)
    p = _softmax(scores, axis=-1)
    o = torch.einsum("bhqk,bhkd->bhqd", p, v_cache)
    return (lambda x, *d: x.permute(*d))(o, 0, 2, 1, 3).reshape(B, Sq, H * Dh) @ wo
```

```asm
; @launch grid=(256,1,1) block=(512,1,1) lds=163840
.amdgcn_target "amdgcn-amd-amdhsa--gfx950"
.text
.globl standalone__mha_block_cached__near_ridge_kernel
.p2align 8
.type standalone__mha_block_cached__near_ridge_kernel,@function
standalone__mha_block_cached__near_ridge_kernel:
    s_cmp_ge_u32 s2, 256
    s_cbranch_scc1 L_done
    s_load_dwordx16 s[52:67], s[0:1], 0
    v_and_b32 v1, 63, v0
    v_lshrrev_b32 v2, 6, v0
    s_nop 0
    v_readfirstlane_b32 s74, v2
    s_lshr_b32 s41, s2, 5
    s_bfe_u32 s87, s2, 0x20003
    s_and_b32 s85, s2, 3
    s_lshr_b32 s51, s41, 1
    s_mul_i32 s51, s51, 4
    s_mul_i32 s42, s87, 4
    s_add_u32 s51, s51, s42
    s_and_b32 s36, s74, 3
    s_and_b32 s37, s2, 4
    s_lshl_b32 s37, s37, 1
    s_add_u32 s37, s37, s41
    s_and_b32 s41, s41, 1
    s_lshl_b32 s42, s85, 3
    s_add_u32 s41, s41, s42
    s_lshl_b32 s42, s87, 1
    s_add_u32 s38, s41, s42
    s_lshl_b32 s50, s36, 12
    s_cmp_lt_u32 s74, 4
    s_cbranch_scc1 L_A
    v_lshrrev_b32 v2, 4, v1
    v_and_b32 v3, 15, v1
    v_lshlrev_b32 v4, 2, v2
    v_xor_b32 v4, v4, v3
    v_lshlrev_b32 v4, 4, v4
    v_lshl_add_u32 v13, v2, 13, v4
    v_lshl_add_u32 v12, v2, 8, v4
    v_lshl_add_u32 v22, v2, 10, v4
    v_lshrrev_b32 v4, 3, v1
    v_and_b32 v5, 7, v1
    v_xor_b32 v5, v5, v2
    v_lshlrev_b32 v5, 4, v5
    v_lshl_add_u32 v20, v4, 10, v5
    v_xor_b32 v21, 64, v20
    s_lshl_b32 s41, s36, 17
    s_lshl_b32 s42, s38, 8
    s_add_u32 s45, s41, s42
    s_xor_b32 s46, s45, 256
    s_lshl_b32 s41, s37, 17
    s_lshl_b32 s42, s36, 15
    s_add_u32 s47, s41, s42
    s_waitcnt lgkmcnt(0)
    s_mov_b32 s20, s52
    s_and_b32 s21, s53, 0xffff
    s_mov_b32 s22, 0x200000
    s_mov_b32 s23, 0x20000
    s_mov_b32 s16, s58
    s_and_b32 s17, s59, 0xffff
    s_mov_b32 s18, 0x400000
    s_mov_b32 s19, 0x20000
    s_add_u32 s42, s51, 0
    s_and_b32 s42, s42, 7
    s_lshl_b32 s42, s42, 7
    s_add_u32 s41, s47, s42
    s_add_u32 m0, s50, 0x20000
    s_nop 0
    buffer_load_dwordx4 v20, s[20:23], s41 offen offset:0 lds
    s_add_u32 s41, s41, 0x1c00
    buffer_load_dwordx4 v21, s[20:23], s41 offen offset:1024 lds
    s_add_u32 s41, s41, 0x1c00
    buffer_load_dwordx4 v20, s[20:23], s41 offen offset:2048 lds
    s_add_u32 s41, s41, 0x1c00
    buffer_load_dwordx4 v21, s[20:23], s41 offen offset:3072 lds
    s_add_u32 s42, s51, 0
    s_and_b32 s42, s42, 7
    s_lshl_b32 s42, s42, 19
    s_add_u32 s41, s45, s42
    s_add_u32 m0, s50, 0x24000
    s_nop 0
    buffer_load_dwordx4 v13, s[16:19], s41 offen offset:0 lds
    s_add_u32 s41, s41, 0x7c00
    buffer_load_dwordx4 v13, s[16:19], s41 offen offset:1024 lds
    s_add_u32 s41, s41, 0x7c00
    buffer_load_dwordx4 v13, s[16:19], s41 offen offset:2048 lds
    s_add_u32 s41, s41, 0x7c00
    buffer_load_dwordx4 v13, s[16:19], s41 offen offset:3072 lds
    s_add_u32 s42, s51, 1
    s_and_b32 s42, s42, 7
    s_lshl_b32 s42, s42, 7
    s_add_u32 s41, s47, s42
    s_add_u32 m0, s50, 0xc000
    s_nop 0
    buffer_load_dwordx4 v20, s[20:23], s41 offen offset:0 lds
    s_add_u32 s41, s41, 0x1c00
    buffer_load_dwordx4 v21, s[20:23], s41 offen offset:1024 lds
    s_add_u32 s41, s41, 0x1c00
    buffer_load_dwordx4 v20, s[20:23], s41 offen offset:2048 lds
    s_add_u32 s41, s41, 0x1c00
    buffer_load_dwordx4 v21, s[20:23], s41 offen offset:3072 lds
    s_add_u32 s42, s51, 1
    s_and_b32 s42, s42, 7
    s_lshl_b32 s42, s42, 19
    s_add_u32 s41, s45, s42
    s_add_u32 m0, s50, 0x10000
    s_nop 0
    buffer_load_dwordx4 v13, s[16:19], s41 offen offset:0 lds
    s_add_u32 s41, s41, 0x7c00
    buffer_load_dwordx4 v13, s[16:19], s41 offen offset:1024 lds
    s_add_u32 s41, s41, 0x7c00
    buffer_load_dwordx4 v13, s[16:19], s41 offen offset:2048 lds
    s_add_u32 s41, s41, 0x7c00
    buffer_load_dwordx4 v13, s[16:19], s41 offen offset:3072 lds
    s_lshr_b32 s41, s2, 5
    s_and_b32 s86, s2, 7
    s_lshl_b32 s86, s86, 3
    s_add_u32 s86, s86, s41
    s_lshl_b32 s86, s86, 8
    s_add_u32 s86, s86, 0x3000000
    s_lshl_b32 s84, s36, 4
    s_add_u32 s84, s84, s86
    s_add_u32 s84, s84, 128
    s_lshl_b32 s99, s37, 2
    s_add_u32 s99, s99, s87
    s_lshl_b32 s99, s99, 8
    s_add_u32 s99, s99, 0x3008000
    s_lshl_b32 s41, s37, 2
    s_add_u32 s41, s41, s36
    s_lshl_b32 s75, s41, 18
    s_mov_b32 s8, s54
    s_and_b32 s9, s55, 0xffff
    s_mov_b32 s10, 0x4000000
    s_mov_b32 s11, 0x20000
    s_mov_b32 s12, s56
    s_and_b32 s13, s57, 0xffff
    s_mov_b32 s14, 0x4000000
    s_mov_b32 s15, 0x20000
    s_mov_b32 s28, s60
    s_and_b32 s29, s61, 0xffff
    s_mov_b32 s30, 0x400000
    s_mov_b32 s31, 0x20000
    s_mov_b32 s32, s62
    s_and_b32 s33, s63, 0xffff
    s_mov_b32 s34, 0x200000
    s_mov_b32 s35, 0x20000
    s_mov_b32 s24, s66
    s_and_b32 s25, s67, 0xffff
    s_mov_b32 s26, 0x10000000
    s_mov_b32 s27, 0x20000
    s_mov_b32 s88, s64
    s_and_b32 s89, s65, 0xffff
    s_mov_b32 s90, 0x100
    s_mov_b32 s91, 0x20000
    v_xor_b32 v4, v2, v3
    v_lshlrev_b32 v2, 8, v2
    v_xor_b32 v5, 0, v4
    v_lshl_add_u32 v8, v5, 4, v2
    v_xor_b32 v5, 4, v4
    v_lshl_add_u32 v9, v5, 4, v2
    v_xor_b32 v5, 8, v4
    v_lshl_add_u32 v10, v5, 4, v2
    v_xor_b32 v5, 12, v4
    v_lshl_add_u32 v11, v5, 4, v2
    s_lshl_b32 s41, s37, 5
    s_add_u32 s41, s41, s38
    s_lshl_b32 s41, s41, 17
    s_add_u32 s39, s41, s50
    s_xor_b32 s40, s39, 0x20000
    s_lshr_b32 s6, s2, 3
    s_and_b32 s41, s38, 0x19
    s_add_u32 s42, s87, 0
    s_and_b32 s42, s42, 3
    s_lshl_b32 s42, s42, 1
    s_add_u32 s92, s41, s42
    s_add_u32 s42, s87, 1
    s_and_b32 s42, s42, 3
    s_lshl_b32 s42, s42, 1
    s_add_u32 s93, s41, s42
    s_add_u32 s42, s87, 2
    s_and_b32 s42, s42, 3
    s_lshl_b32 s42, s42, 1
    s_add_u32 s94, s41, s42
    s_add_u32 s42, s87, 3
    s_and_b32 s42, s42, 3
    s_lshl_b32 s42, s42, 1
    s_add_u32 s95, s41, s42
    v_lshlrev_b32 v7, 4, v1
    v_mov_b32 v6, 0
    s_mov_b32 s44, 0x3e0293ee
    v_bfe_u32 v2, v1, 2, 2
    v_lshrrev_b32 v3, 5, v1
    v_mad_u32_u24 v3, v3, 8, v2
    v_lshlrev_b32 v3, 8, v3
    v_and_b32 v4, 16, v1
    v_lshl_add_u32 v3, v4, 1, v3
    v_and_b32 v4, 1, v1
    v_lshl_add_u32 v3, v4, 4, v3
    v_and_b32 v4, 2, v1
    v_lshl_add_u32 v3, v4, 2, v3
    v_xor_b32 v4, 0, v2
    v_lshl_add_u32 v28, v4, 6, v3
    v_xor_b32 v4, 1, v2
    v_lshl_add_u32 v29, v4, 6, v3
    v_xor_b32 v4, 2, v2
    v_lshl_add_u32 v30, v4, 6, v3
    v_xor_b32 v4, 3, v2
    v_lshl_add_u32 v31, v4, 6, v3
    v_bfe_u32 v2, v1, 1, 3
    v_lshrrev_b32 v3, 5, v1
    v_xor_b32 v2, v2, v3
    v_and_b32 v3, 31, v1
    v_lshlrev_b32 v3, 7, v3
    v_add_u32 v3, s50, v3
    v_xor_b32 v4, 0, v2
    v_lshl_add_u32 v16, v4, 4, v3
    v_xor_b32 v4, 2, v2
    v_lshl_add_u32 v17, v4, 4, v3
    v_xor_b32 v4, 4, v2
    v_lshl_add_u32 v18, v4, 4, v3
    v_xor_b32 v4, 6, v2
    v_lshl_add_u32 v19, v4, 4, v3
    s_lshl_b32 s41, s36, 13
    s_add_u32 s41, s41, 0x18000
    v_add_u32 v14, s41, v7
    v_add_u32 v16, 0x20000, v16
    v_add_u32 v17, 0x20000, v17
    v_add_u32 v18, 0x20000, v18
    v_add_u32 v19, 0x20000, v19
    s_waitcnt vmcnt(8) lgkmcnt(0)
    s_barrier
    ds_read_b128 v[128:131], v16
    ds_read_b128 v[132:135], v17
    ds_read_b128 v[136:139], v18
    ds_read_b128 v[140:143], v19
    s_add_u32 s42, s51, 2
    s_and_b32 s42, s42, 7
    s_lshl_b32 s42, s42, 7
    s_add_u32 s41, s47, s42
    s_add_u32 m0, s50, 0x14000
    s_nop 0
    buffer_load_dwordx4 v20, s[20:23], s41 offen offset:0 lds
    s_add_u32 s41, s41, 0x1c00
    buffer_load_dwordx4 v21, s[20:23], s41 offen offset:1024 lds
    s_add_u32 s41, s41, 0x1c00
    buffer_load_dwordx4 v20, s[20:23], s41 offen offset:2048 lds
    s_add_u32 s41, s41, 0x1c00
    buffer_load_dwordx4 v21, s[20:23], s41 offen offset:3072 lds
    s_add_u32 s42, s51, 2
    s_and_b32 s42, s42, 7
    s_lshl_b32 s42, s42, 19
    s_add_u32 s41, s45, s42
    s_add_u32 m0, s50, 0x8000
    s_nop 0
    buffer_load_dwordx4 v13, s[16:19], s41 offen offset:0 lds
    s_add_u32 s41, s41, 0x7c00
    buffer_load_dwordx4 v13, s[16:19], s41 offen offset:1024 lds
    s_add_u32 s41, s41, 0x7c00
    buffer_load_dwordx4 v13, s[16:19], s41 offen offset:2048 lds
    s_add_u32 s41, s41, 0x7c00
    buffer_load_dwordx4 v13, s[16:19], s41 offen offset:3072 lds
    v_add_u32 v16, 0xfffec000, v16
    v_add_u32 v17, 0xfffec000, v17
    v_add_u32 v18, 0xfffec000, v18
    v_add_u32 v19, 0xfffec000, v19
    s_waitcnt vmcnt(8) lgkmcnt(0)
    s_barrier
    ds_read_b128 v[144:147], v16
    ds_read_b128 v[148:151], v17
    ds_read_b128 v[152:155], v18
    ds_read_b128 v[156:159], v19
    s_add_u32 s42, s51, 3
    s_and_b32 s42, s42, 7
    s_lshl_b32 s42, s42, 7
    s_add_u32 s41, s47, s42
    s_add_u32 m0, s50, 0x18000
    s_nop 0
    buffer_load_dwordx4 v20, s[20:23], s41 offen offset:0 lds
    s_add_u32 s41, s41, 0x1c00
    buffer_load_dwordx4 v21, s[20:23], s41 offen offset:1024 lds
    s_add_u32 s41, s41, 0x1c00
    buffer_load_dwordx4 v20, s[20:23], s41 offen offset:2048 lds
    s_add_u32 s41, s41, 0x1c00
    buffer_load_dwordx4 v21, s[20:23], s41 offen offset:3072 lds
    s_add_u32 s42, s51, 3
    s_and_b32 s42, s42, 7
    s_lshl_b32 s42, s42, 19
    s_add_u32 s41, s45, s42
    s_add_u32 m0, s50, 0x1c000
    s_nop 0
    buffer_load_dwordx4 v13, s[16:19], s41 offen offset:0 lds
    s_add_u32 s41, s41, 0x7c00
    buffer_load_dwordx4 v13, s[16:19], s41 offen offset:1024 lds
    s_add_u32 s41, s41, 0x7c00
    buffer_load_dwordx4 v13, s[16:19], s41 offen offset:2048 lds
    s_add_u32 s41, s41, 0x7c00
    buffer_load_dwordx4 v13, s[16:19], s41 offen offset:3072 lds
    v_add_u32 v16, 0x8000, v16
    v_add_u32 v17, 0x8000, v17
    v_add_u32 v18, 0x8000, v18
    v_add_u32 v19, 0x8000, v19
    s_waitcnt vmcnt(8) lgkmcnt(0)
    s_barrier
    ds_read_b128 v[160:163], v16
    ds_read_b128 v[164:167], v17
    ds_read_b128 v[168:171], v18
    ds_read_b128 v[172:175], v19
    s_add_u32 s42, s51, 4
    s_and_b32 s42, s42, 7
    s_lshl_b32 s42, s42, 7
    s_add_u32 s41, s47, s42
    s_add_u32 m0, s50, 0x20000
    s_nop 0
    buffer_load_dwordx4 v20, s[20:23], s41 offen offset:0 lds
    s_add_u32 s41, s41, 0x1c00
    buffer_load_dwordx4 v21, s[20:23], s41 offen offset:1024 lds
    s_add_u32 s41, s41, 0x1c00
    buffer_load_dwordx4 v20, s[20:23], s41 offen offset:2048 lds
    s_add_u32 s41, s41, 0x1c00
    buffer_load_dwordx4 v21, s[20:23], s41 offen offset:3072 lds
    s_add_u32 s42, s51, 4
    s_and_b32 s42, s42, 7
    s_lshl_b32 s42, s42, 19
    s_add_u32 s41, s45, s42
    s_add_u32 m0, s50, 0x24000
    s_nop 0
    buffer_load_dwordx4 v13, s[16:19], s41 offen offset:0 lds
    s_add_u32 s41, s41, 0x7c00
    buffer_load_dwordx4 v13, s[16:19], s41 offen offset:1024 lds
    s_add_u32 s41, s41, 0x7c00
    buffer_load_dwordx4 v13, s[16:19], s41 offen offset:2048 lds
    s_add_u32 s41, s41, 0x7c00
    buffer_load_dwordx4 v13, s[16:19], s41 offen offset:3072 lds
    s_add_u32 s42, s6, 0
    s_and_b32 s42, s42, 7
    s_lshl_b32 s42, s42, 14
    s_add_u32 s41, s39, s42
    s_add_u32 m0, s50, 0x0
    s_nop 0
    buffer_load_dwordx4 v8, s[8:11], s41 offen offset:0 nt lds
    buffer_load_dwordx4 v9, s[8:11], s41 offen offset:1024 nt lds
    buffer_load_dwordx4 v10, s[8:11], s41 offen offset:2048 nt lds
    buffer_load_dwordx4 v11, s[8:11], s41 offen offset:3072 nt lds
    v_add_u32 v16, 0x4000, v16
    v_add_u32 v17, 0x4000, v17
    v_add_u32 v18, 0x4000, v18
    v_add_u32 v19, 0x4000, v19
    s_waitcnt vmcnt(12) lgkmcnt(0)
    s_barrier
    ds_read_b128 v[176:179], v16
    ds_read_b128 v[180:183], v17
    ds_read_b128 v[184:187], v18
    ds_read_b128 v[188:191], v19
    s_add_u32 s42, s51, 5
    s_and_b32 s42, s42, 7
    s_lshl_b32 s42, s42, 7
    s_add_u32 s41, s47, s42
    s_add_u32 m0, s50, 0xc000
    s_nop 0
    buffer_load_dwordx4 v20, s[20:23], s41 offen offset:0 lds
    s_add_u32 s41, s41, 0x1c00
    buffer_load_dwordx4 v21, s[20:23], s41 offen offset:1024 lds
    s_add_u32 s41, s41, 0x1c00
    buffer_load_dwordx4 v20, s[20:23], s41 offen offset:2048 lds
    s_add_u32 s41, s41, 0x1c00
    buffer_load_dwordx4 v21, s[20:23], s41 offen offset:3072 lds
    s_add_u32 s42, s51, 5
    s_and_b32 s42, s42, 7
    s_lshl_b32 s42, s42, 19
    s_add_u32 s41, s45, s42
    s_add_u32 m0, s50, 0x10000
    s_nop 0
    buffer_load_dwordx4 v13, s[16:19], s41 offen offset:0 lds
    s_add_u32 s41, s41, 0x7c00
    buffer_load_dwordx4 v13, s[16:19], s41 offen offset:1024 lds
    s_add_u32 s41, s41, 0x7c00
    buffer_load_dwordx4 v13, s[16:19], s41 offen offset:2048 lds
    s_add_u32 s41, s41, 0x7c00
    buffer_load_dwordx4 v13, s[16:19], s41 offen offset:3072 lds
    s_add_u32 s42, s6, 1
    s_and_b32 s42, s42, 7
    s_lshl_b32 s42, s42, 14
    s_add_u32 s41, s39, s42
    s_add_u32 m0, s50, 0x4000
    s_nop 0
    buffer_load_dwordx4 v8, s[8:11], s41 offen offset:0 nt lds
    buffer_load_dwordx4 v9, s[8:11], s41 offen offset:1024 nt lds
    buffer_load_dwordx4 v10, s[8:11], s41 offen offset:2048 nt lds
    buffer_load_dwordx4 v11, s[8:11], s41 offen offset:3072 nt lds
    v_add_u32 v16, 0x8000, v16
    v_add_u32 v17, 0x8000, v17
    v_add_u32 v18, 0x8000, v18
    v_add_u32 v19, 0x8000, v19
    s_waitcnt vmcnt(16) lgkmcnt(0)
    s_barrier
    ds_read_b128 v[192:195], v16
    ds_read_b128 v[196:199], v17
    ds_read_b128 v[200:203], v18
    ds_read_b128 v[204:207], v19
    s_add_u32 s42, s51, 6
    s_and_b32 s42, s42, 7
    s_lshl_b32 s42, s42, 7
    s_add_u32 s41, s47, s42
    s_add_u32 m0, s50, 0x14000
    s_nop 0
    buffer_load_dwordx4 v20, s[20:23], s41 offen offset:0 lds
    s_add_u32 s41, s41, 0x1c00
    buffer_load_dwordx4 v21, s[20:23], s41 offen offset:1024 lds
    s_add_u32 s41, s41, 0x1c00
    buffer_load_dwordx4 v20, s[20:23], s41 offen offset:2048 lds
    s_add_u32 s41, s41, 0x1c00
    buffer_load_dwordx4 v21, s[20:23], s41 offen offset:3072 lds
    s_add_u32 s42, s51, 6
    s_and_b32 s42, s42, 7
    s_lshl_b32 s42, s42, 19
    s_add_u32 s41, s45, s42
    s_add_u32 m0, s50, 0x8000
    s_nop 0
    buffer_load_dwordx4 v13, s[16:19], s41 offen offset:0 lds
    s_add_u32 s41, s41, 0x7c00
    buffer_load_dwordx4 v13, s[16:19], s41 offen offset:1024 lds
    s_add_u32 s41, s41, 0x7c00
    buffer_load_dwordx4 v13, s[16:19], s41 offen offset:2048 lds
    s_add_u32 s41, s41, 0x7c00
    buffer_load_dwordx4 v13, s[16:19], s41 offen offset:3072 lds
    v_add_u32 v16, 0xfffec000, v16
    v_add_u32 v17, 0xfffec000, v17
    v_add_u32 v18, 0xfffec000, v18
    v_add_u32 v19, 0xfffec000, v19
    s_waitcnt vmcnt(12) lgkmcnt(0)
    s_barrier
    ds_read_b128 v[208:211], v16
    ds_read_b128 v[212:215], v17
    ds_read_b128 v[216:219], v18
    ds_read_b128 v[220:223], v19
    s_add_u32 s42, s51, 7
    s_and_b32 s42, s42, 7
    s_lshl_b32 s42, s42, 7
    s_add_u32 s41, s47, s42
    s_add_u32 m0, s50, 0x18000
    s_nop 0
    buffer_load_dwordx4 v20, s[20:23], s41 offen offset:0 lds
    s_add_u32 s41, s41, 0x1c00
    buffer_load_dwordx4 v21, s[20:23], s41 offen offset:1024 lds
    s_add_u32 s41, s41, 0x1c00
    buffer_load_dwordx4 v20, s[20:23], s41 offen offset:2048 lds
    s_add_u32 s41, s41, 0x1c00
    buffer_load_dwordx4 v21, s[20:23], s41 offen offset:3072 lds
    s_add_u32 s42, s51, 7
    s_and_b32 s42, s42, 7
    s_lshl_b32 s42, s42, 19
    s_add_u32 s41, s45, s42
    s_add_u32 m0, s50, 0x1c000
    s_nop 0
    buffer_load_dwordx4 v13, s[16:19], s41 offen offset:0 lds
    s_add_u32 s41, s41, 0x7c00
    buffer_load_dwordx4 v13, s[16:19], s41 offen offset:1024 lds
    s_add_u32 s41, s41, 0x7c00
    buffer_load_dwordx4 v13, s[16:19], s41 offen offset:2048 lds
    s_add_u32 s41, s41, 0x7c00
    buffer_load_dwordx4 v13, s[16:19], s41 offen offset:3072 lds
    v_add_u32 v16, 0x8000, v16
    v_add_u32 v17, 0x8000, v17
    v_add_u32 v18, 0x8000, v18
    v_add_u32 v19, 0x8000, v19
    s_waitcnt vmcnt(8) lgkmcnt(0)
    s_barrier
    ds_read_b128 v[224:227], v16
    ds_read_b128 v[228:231], v17
    ds_read_b128 v[232:235], v18
    ds_read_b128 v[236:239], v19
    s_add_u32 s42, s51, 0
    s_and_b32 s42, s42, 7
    s_lshl_b32 s42, s42, 19
    s_add_u32 s41, s46, s42
    s_add_u32 m0, s50, 0x20000
    s_nop 0
    buffer_load_dwordx4 v13, s[16:19], s41 offen offset:0 lds
    s_add_u32 s41, s41, 0x7c00
    buffer_load_dwordx4 v13, s[16:19], s41 offen offset:1024 lds
    s_add_u32 s41, s41, 0x7c00
    buffer_load_dwordx4 v13, s[16:19], s41 offen offset:2048 lds
    s_add_u32 s41, s41, 0x7c00
    buffer_load_dwordx4 v13, s[16:19], s41 offen offset:3072 lds
    v_add_u32 v16, 0x4000, v16
    v_add_u32 v17, 0x4000, v17
    v_add_u32 v18, 0x4000, v18
    v_add_u32 v19, 0x4000, v19
    s_waitcnt vmcnt(4) lgkmcnt(0)
    s_barrier
    ds_read_b128 v[240:243], v16
    ds_read_b128 v[244:247], v17
    ds_read_b128 v[248:251], v18
    ds_read_b128 v[252:255], v19
    s_add_u32 s42, s6, 0
    s_and_b32 s42, s42, 7
    s_lshl_b32 s42, s42, 14
    s_add_u32 s41, s39, s42
    s_add_u32 m0, s50, 0xc000
    s_nop 0
    buffer_load_dwordx4 v12, s[12:15], s41 offen offset:0 nt lds
    buffer_load_dwordx4 v12, s[12:15], s41 offen offset:1024 nt lds
    buffer_load_dwordx4 v12, s[12:15], s41 offen offset:2048 nt lds
    buffer_load_dwordx4 v12, s[12:15], s41 offen offset:3072 nt lds
    s_lshl_b32 s41, s36, 14
    s_lshl_b32 s42, s87, 8
    s_add_u32 s47, s41, s42
    s_waitcnt vmcnt(4) lgkmcnt(0)
    s_barrier
    v_add_u32 v28, 0x20000, v28
    v_add_u32 v29, 0x20000, v29
    v_add_u32 v30, 0x20000, v30
    v_add_u32 v31, 0x20000, v31
    ds_read_b64_tr_b16 v[32:33], v28 offset:0
    ds_read_b64_tr_b16 v[34:35], v28 offset:1024
    ds_read_b64_tr_b16 v[36:37], v29 offset:0
    ds_read_b64_tr_b16 v[38:39], v29 offset:1024
    ds_read_b64_tr_b16 v[40:41], v30 offset:0
    ds_read_b64_tr_b16 v[42:43], v30 offset:1024
    ds_read_b64_tr_b16 v[44:45], v31 offset:0
    ds_read_b64_tr_b16 v[46:47], v31 offset:1024
    ds_read_b64_tr_b16 v[48:49], v28 offset:4096
    ds_read_b64_tr_b16 v[50:51], v28 offset:5120
    s_waitcnt lgkmcnt(8)
    v_mfma_f32_32x32x16_bf16 v[64:79], v[32:35], v[128:131], 0
    ds_read_b64_tr_b16 v[52:53], v29 offset:4096
    ds_read_b64_tr_b16 v[54:55], v29 offset:5120
    s_add_u32 s42, s51, 1
    s_and_b32 s42, s42, 7
    s_lshl_b32 s42, s42, 19
    s_add_u32 s41, s46, s42
    s_add_u32 m0, s50, 0x24000
    s_nop 0
    buffer_load_dwordx4 v13, s[16:19], s41 offen offset:0 lds
    s_waitcnt lgkmcnt(8)
    v_mfma_f32_32x32x16_bf16 v[80:95], v[36:39], v[128:131], 0
    ds_read_b64_tr_b16 v[56:57], v30 offset:4096
    ds_read_b64_tr_b16 v[58:59], v30 offset:5120
    s_add_u32 s41, s41, 0x7c00
    buffer_load_dwordx4 v13, s[16:19], s41 offen offset:1024 lds
    s_add_u32 s41, s41, 0x7c00
    buffer_load_dwordx4 v13, s[16:19], s41 offen offset:2048 lds
    s_waitcnt lgkmcnt(8)
    v_mfma_f32_32x32x16_bf16 v[96:111], v[40:43], v[128:131], 0
    ds_read_b64_tr_b16 v[60:61], v31 offset:4096
    ds_read_b64_tr_b16 v[62:63], v31 offset:5120
    s_add_u32 s41, s41, 0x7c00
    buffer_load_dwordx4 v13, s[16:19], s41 offen offset:3072 lds
    s_waitcnt lgkmcnt(8)
    v_mfma_f32_32x32x16_bf16 v[112:127], v[44:47], v[128:131], 0
    ds_read_b64_tr_b16 v[32:33], v28 offset:8192
    ds_read_b64_tr_b16 v[34:35], v28 offset:9216
    s_add_u32 s42, s6, 1
    s_and_b32 s42, s42, 7
    s_lshl_b32 s42, s42, 14
    s_add_u32 s41, s39, s42
    s_add_u32 m0, s50, 0x10000
    s_nop 0
    buffer_load_dwordx4 v12, s[12:15], s41 offen offset:0 nt lds
    buffer_load_dwordx4 v12, s[12:15], s41 offen offset:1024 nt lds
    s_waitcnt lgkmcnt(8)
    v_mfma_f32_32x32x16_bf16 v[64:79], v[48:51], v[132:135], v[64:79]
    ds_read_b64_tr_b16 v[36:37], v29 offset:8192
    ds_read_b64_tr_b16 v[38:39], v29 offset:9216
    buffer_load_dwordx4 v12, s[12:15], s41 offen offset:2048 nt lds
    s_waitcnt lgkmcnt(8)
    v_mfma_f32_32x32x16_bf16 v[80:95], v[52:55], v[132:135], v[80:95]
    ds_read_b64_tr_b16 v[40:41], v30 offset:8192
    ds_read_b64_tr_b16 v[42:43], v30 offset:9216
    buffer_load_dwordx4 v12, s[12:15], s41 offen offset:3072 nt lds
    s_add_u32 s42, s6, 2
    s_and_b32 s42, s42, 7
    s_lshl_b32 s42, s42, 14
    s_add_u32 s41, s39, s42
    s_add_u32 m0, s50, 0x8000
    s_nop 0
    buffer_load_dwordx4 v8, s[8:11], s41 offen offset:0 nt lds
    s_waitcnt lgkmcnt(8)
    v_mfma_f32_32x32x16_bf16 v[96:111], v[56:59], v[132:135], v[96:111]
    ds_read_b64_tr_b16 v[44:45], v31 offset:8192
    ds_read_b64_tr_b16 v[46:47], v31 offset:9216
    buffer_load_dwordx4 v9, s[8:11], s41 offen offset:1024 nt lds
    s_waitcnt lgkmcnt(8)
    v_mfma_f32_32x32x16_bf16 v[112:127], v[60:63], v[132:135], v[112:127]
    ds_read_b64_tr_b16 v[48:49], v28 offset:12288
    ds_read_b64_tr_b16 v[50:51], v28 offset:13312
    buffer_load_dwordx4 v10, s[8:11], s41 offen offset:2048 nt lds
    buffer_load_dwordx4 v11, s[8:11], s41 offen offset:3072 nt lds
    s_waitcnt lgkmcnt(8)
    v_mfma_f32_32x32x16_bf16 v[64:79], v[32:35], v[136:139], v[64:79]
    ds_read_b64_tr_b16 v[52:53], v29 offset:12288
    ds_read_b64_tr_b16 v[54:55], v29 offset:13312
    s_waitcnt lgkmcnt(8)
    v_mfma_f32_32x32x16_bf16 v[80:95], v[36:39], v[136:139], v[80:95]
    ds_read_b64_tr_b16 v[56:57], v30 offset:12288
    ds_read_b64_tr_b16 v[58:59], v30 offset:13312
    s_waitcnt lgkmcnt(8)
    v_mfma_f32_32x32x16_bf16 v[96:111], v[40:43], v[136:139], v[96:111]
    ds_read_b64_tr_b16 v[60:61], v31 offset:12288
    ds_read_b64_tr_b16 v[62:63], v31 offset:13312
    s_waitcnt lgkmcnt(8)
    v_mfma_f32_32x32x16_bf16 v[112:127], v[44:47], v[136:139], v[112:127]
    s_waitcnt lgkmcnt(6)
    v_mfma_f32_32x32x16_bf16 v[64:79], v[48:51], v[140:143], v[64:79]
    s_waitcnt lgkmcnt(4)
    v_mfma_f32_32x32x16_bf16 v[80:95], v[52:55], v[140:143], v[80:95]
    s_waitcnt lgkmcnt(2)
    v_mfma_f32_32x32x16_bf16 v[96:111], v[56:59], v[140:143], v[96:111]
    s_waitcnt lgkmcnt(0)
    v_mfma_f32_32x32x16_bf16 v[112:127], v[60:63], v[140:143], v[112:127]
    s_waitcnt vmcnt(8) lgkmcnt(0)
    s_barrier
    ds_read_b64_tr_b16 v[32:33], v28 offset:16384
    ds_read_b64_tr_b16 v[34:35], v28 offset:17408
    ds_read_b64_tr_b16 v[36:37], v29 offset:16384
    ds_read_b64_tr_b16 v[38:39], v29 offset:17408
    ds_read_b64_tr_b16 v[40:41], v30 offset:16384
    ds_read_b64_tr_b16 v[42:43], v30 offset:17408
    ds_read_b64_tr_b16 v[44:45], v31 offset:16384
    ds_read_b64_tr_b16 v[46:47], v31 offset:17408
    ds_read_b64_tr_b16 v[48:49], v28 offset:20480
    ds_read_b64_tr_b16 v[50:51], v28 offset:21504
    s_waitcnt lgkmcnt(8)
    v_mfma_f32_32x32x16_bf16 v[64:79], v[32:35], v[144:147], v[64:79]
    ds_read_b64_tr_b16 v[52:53], v29 offset:20480
    ds_read_b64_tr_b16 v[54:55], v29 offset:21504
    s_add_u32 s42, s51, 2
    s_and_b32 s42, s42, 7
    s_lshl_b32 s42, s42, 19
    s_add_u32 s41, s46, s42
    s_add_u32 m0, s50, 0x20000
    s_nop 0
    buffer_load_dwordx4 v13, s[16:19], s41 offen offset:0 lds
    s_waitcnt lgkmcnt(8)
    v_mfma_f32_32x32x16_bf16 v[80:95], v[36:39], v[144:147], v[80:95]
    ds_read_b64_tr_b16 v[56:57], v30 offset:20480
    ds_read_b64_tr_b16 v[58:59], v30 offset:21504
    s_add_u32 s41, s41, 0x7c00
    buffer_load_dwordx4 v13, s[16:19], s41 offen offset:1024 lds
    s_add_u32 s41, s41, 0x7c00
    buffer_load_dwordx4 v13, s[16:19], s41 offen offset:2048 lds
    s_waitcnt lgkmcnt(8)
    v_mfma_f32_32x32x16_bf16 v[96:111], v[40:43], v[144:147], v[96:111]
    ds_read_b64_tr_b16 v[60:61], v31 offset:20480
    ds_read_b64_tr_b16 v[62:63], v31 offset:21504
    s_add_u32 s41, s41, 0x7c00
    buffer_load_dwordx4 v13, s[16:19], s41 offen offset:3072 lds
    s_waitcnt lgkmcnt(8)
    v_mfma_f32_32x32x16_bf16 v[112:127], v[44:47], v[144:147], v[112:127]
    ds_read_b64_tr_b16 v[32:33], v28 offset:24576
    ds_read_b64_tr_b16 v[34:35], v28 offset:25600
    s_add_u32 s42, s6, 3
    s_and_b32 s42, s42, 7
    s_lshl_b32 s42, s42, 14
    s_add_u32 s41, s39, s42
    s_add_u32 m0, s50, 0x0
    s_nop 0
    buffer_load_dwordx4 v8, s[8:11], s41 offen offset:0 nt lds
    buffer_load_dwordx4 v9, s[8:11], s41 offen offset:1024 nt lds
    s_waitcnt lgkmcnt(8)
    v_mfma_f32_32x32x16_bf16 v[64:79], v[48:51], v[148:151], v[64:79]
    ds_read_b64_tr_b16 v[36:37], v29 offset:24576
    ds_read_b64_tr_b16 v[38:39], v29 offset:25600
    buffer_load_dwordx4 v10, s[8:11], s41 offen offset:2048 nt lds
    s_waitcnt lgkmcnt(8)
    v_mfma_f32_32x32x16_bf16 v[80:95], v[52:55], v[148:151], v[80:95]
    ds_read_b64_tr_b16 v[40:41], v30 offset:24576
    ds_read_b64_tr_b16 v[42:43], v30 offset:25600
    buffer_load_dwordx4 v11, s[8:11], s41 offen offset:3072 nt lds
    s_add_u32 s42, s6, 2
    s_and_b32 s42, s42, 7
    s_lshl_b32 s42, s42, 14
    s_add_u32 s41, s39, s42
    s_add_u32 m0, s50, 0x14000
    s_nop 0
    buffer_load_dwordx4 v12, s[12:15], s41 offen offset:0 nt lds
    s_waitcnt lgkmcnt(8)
    v_mfma_f32_32x32x16_bf16 v[96:111], v[56:59], v[148:151], v[96:111]
    ds_read_b64_tr_b16 v[44:45], v31 offset:24576
    ds_read_b64_tr_b16 v[46:47], v31 offset:25600
    buffer_load_dwordx4 v12, s[12:15], s41 offen offset:1024 nt lds
    s_waitcnt lgkmcnt(8)
    v_mfma_f32_32x32x16_bf16 v[112:127], v[60:63], v[148:151], v[112:127]
    ds_read_b64_tr_b16 v[48:49], v28 offset:28672
    ds_read_b64_tr_b16 v[50:51], v28 offset:29696
    buffer_load_dwordx4 v12, s[12:15], s41 offen offset:2048 nt lds
    buffer_load_dwordx4 v12, s[12:15], s41 offen offset:3072 nt lds
    s_waitcnt lgkmcnt(8)
    v_mfma_f32_32x32x16_bf16 v[64:79], v[32:35], v[152:155], v[64:79]
    ds_read_b64_tr_b16 v[52:53], v29 offset:28672
    ds_read_b64_tr_b16 v[54:55], v29 offset:29696
    s_waitcnt lgkmcnt(8)
    v_mfma_f32_32x32x16_bf16 v[80:95], v[36:39], v[152:155], v[80:95]
    ds_read_b64_tr_b16 v[56:57], v30 offset:28672
    ds_read_b64_tr_b16 v[58:59], v30 offset:29696
    s_waitcnt lgkmcnt(8)
    v_mfma_f32_32x32x16_bf16 v[96:111], v[40:43], v[152:155], v[96:111]
    ds_read_b64_tr_b16 v[60:61], v31 offset:28672
    ds_read_b64_tr_b16 v[62:63], v31 offset:29696
    s_waitcnt lgkmcnt(8)
    v_mfma_f32_32x32x16_bf16 v[112:127], v[44:47], v[152:155], v[112:127]
    s_waitcnt lgkmcnt(6)
    v_mfma_f32_32x32x16_bf16 v[64:79], v[48:51], v[156:159], v[64:79]
    s_waitcnt lgkmcnt(4)
    v_mfma_f32_32x32x16_bf16 v[80:95], v[52:55], v[156:159], v[80:95]
    s_waitcnt lgkmcnt(2)
    v_mfma_f32_32x32x16_bf16 v[96:111], v[56:59], v[156:159], v[96:111]
    s_waitcnt lgkmcnt(0)
    v_mfma_f32_32x32x16_bf16 v[112:127], v[60:63], v[156:159], v[112:127]
    s_waitcnt vmcnt(8) lgkmcnt(0)
    s_barrier
    ds_read_b64_tr_b16 v[32:33], v28 offset:0
    ds_read_b64_tr_b16 v[34:35], v28 offset:1024
    ds_read_b64_tr_b16 v[36:37], v29 offset:0
    ds_read_b64_tr_b16 v[38:39], v29 offset:1024
    ds_read_b64_tr_b16 v[40:41], v30 offset:0
    ds_read_b64_tr_b16 v[42:43], v30 offset:1024
    ds_read_b64_tr_b16 v[44:45], v31 offset:0
    ds_read_b64_tr_b16 v[46:47], v31 offset:1024
    ds_read_b64_tr_b16 v[48:49], v28 offset:4096
    ds_read_b64_tr_b16 v[50:51], v28 offset:5120
    s_waitcnt lgkmcnt(8)
    v_mfma_f32_32x32x16_bf16 v[64:79], v[32:35], v[160:163], v[64:79]
    ds_read_b64_tr_b16 v[52:53], v29 offset:4096
    ds_read_b64_tr_b16 v[54:55], v29 offset:5120
    s_add_u32 s42, s51, 3
    s_and_b32 s42, s42, 7
    s_lshl_b32 s42, s42, 19
    s_add_u32 s41, s46, s42
    s_add_u32 m0, s50, 0x24000
    s_nop 0
    buffer_load_dwordx4 v13, s[16:19], s41 offen offset:0 lds
    s_waitcnt lgkmcnt(8)
    v_mfma_f32_32x32x16_bf16 v[80:95], v[36:39], v[160:163], v[80:95]
    ds_read_b64_tr_b16 v[56:57], v30 offset:4096
    ds_read_b64_tr_b16 v[58:59], v30 offset:5120
    s_add_u32 s41, s41, 0x7c00
    buffer_load_dwordx4 v13, s[16:19], s41 offen offset:1024 lds
    s_add_u32 s41, s41, 0x7c00
    buffer_load_dwordx4 v13, s[16:19], s41 offen offset:2048 lds
    s_waitcnt lgkmcnt(8)
    v_mfma_f32_32x32x16_bf16 v[96:111], v[40:43], v[160:163], v[96:111]
    ds_read_b64_tr_b16 v[60:61], v31 offset:4096
    ds_read_b64_tr_b16 v[62:63], v31 offset:5120
    s_add_u32 s41, s41, 0x7c00
    buffer_load_dwordx4 v13, s[16:19], s41 offen offset:3072 lds
    s_waitcnt lgkmcnt(8)
    v_mfma_f32_32x32x16_bf16 v[112:127], v[44:47], v[160:163], v[112:127]
    ds_read_b64_tr_b16 v[32:33], v28 offset:8192
    ds_read_b64_tr_b16 v[34:35], v28 offset:9216
    s_add_u32 s42, s6, 4
    s_and_b32 s42, s42, 7
    s_lshl_b32 s42, s42, 14
    s_add_u32 s41, s39, s42
    s_add_u32 m0, s50, 0x4000
    s_nop 0
    buffer_load_dwordx4 v8, s[8:11], s41 offen offset:0 nt lds
    buffer_load_dwordx4 v9, s[8:11], s41 offen offset:1024 nt lds
    s_waitcnt lgkmcnt(8)
    v_mfma_f32_32x32x16_bf16 v[64:79], v[48:51], v[164:167], v[64:79]
    ds_read_b64_tr_b16 v[36:37], v29 offset:8192
    ds_read_b64_tr_b16 v[38:39], v29 offset:9216
    buffer_load_dwordx4 v10, s[8:11], s41 offen offset:2048 nt lds
    s_waitcnt lgkmcnt(8)
    v_mfma_f32_32x32x16_bf16 v[80:95], v[52:55], v[164:167], v[80:95]
    ds_read_b64_tr_b16 v[40:41], v30 offset:8192
    ds_read_b64_tr_b16 v[42:43], v30 offset:9216
    buffer_load_dwordx4 v11, s[8:11], s41 offen offset:3072 nt lds
    s_add_u32 s42, s6, 3
    s_and_b32 s42, s42, 7
    s_lshl_b32 s42, s42, 14
    s_add_u32 s41, s39, s42
    s_add_u32 m0, s50, 0xc000
    s_nop 0
    buffer_load_dwordx4 v12, s[12:15], s41 offen offset:0 nt lds
    s_waitcnt lgkmcnt(8)
    v_mfma_f32_32x32x16_bf16 v[96:111], v[56:59], v[164:167], v[96:111]
    ds_read_b64_tr_b16 v[44:45], v31 offset:8192
    ds_read_b64_tr_b16 v[46:47], v31 offset:9216
    buffer_load_dwordx4 v12, s[12:15], s41 offen offset:1024 nt lds
    s_waitcnt lgkmcnt(8)
    v_mfma_f32_32x32x16_bf16 v[112:127], v[60:63], v[164:167], v[112:127]
    ds_read_b64_tr_b16 v[48:49], v28 offset:12288
    ds_read_b64_tr_b16 v[50:51], v28 offset:13312
    buffer_load_dwordx4 v12, s[12:15], s41 offen offset:2048 nt lds
    buffer_load_dwordx4 v12, s[12:15], s41 offen offset:3072 nt lds
    s_waitcnt lgkmcnt(8)
    v_mfma_f32_32x32x16_bf16 v[64:79], v[32:35], v[168:171], v[64:79]
    ds_read_b64_tr_b16 v[52:53], v29 offset:12288
    ds_read_b64_tr_b16 v[54:55], v29 offset:13312
    s_waitcnt lgkmcnt(8)
    v_mfma_f32_32x32x16_bf16 v[80:95], v[36:39], v[168:171], v[80:95]
    ds_read_b64_tr_b16 v[56:57], v30 offset:12288
    ds_read_b64_tr_b16 v[58:59], v30 offset:13312
    s_waitcnt lgkmcnt(8)
    v_mfma_f32_32x32x16_bf16 v[96:111], v[40:43], v[168:171], v[96:111]
    ds_read_b64_tr_b16 v[60:61], v31 offset:12288
    ds_read_b64_tr_b16 v[62:63], v31 offset:13312
    s_waitcnt lgkmcnt(8)
    v_mfma_f32_32x32x16_bf16 v[112:127], v[44:47], v[168:171], v[112:127]
    s_waitcnt lgkmcnt(6)
    v_mfma_f32_32x32x16_bf16 v[64:79], v[48:51], v[172:175], v[64:79]
    s_waitcnt lgkmcnt(4)
    v_mfma_f32_32x32x16_bf16 v[80:95], v[52:55], v[172:175], v[80:95]
    s_waitcnt lgkmcnt(2)
    v_mfma_f32_32x32x16_bf16 v[96:111], v[56:59], v[172:175], v[96:111]
    s_waitcnt lgkmcnt(0)
    v_mfma_f32_32x32x16_bf16 v[112:127], v[60:63], v[172:175], v[112:127]
    s_waitcnt vmcnt(8) lgkmcnt(0)
    s_barrier
    ds_read_b64_tr_b16 v[32:33], v28 offset:16384
    ds_read_b64_tr_b16 v[34:35], v28 offset:17408
    ds_read_b64_tr_b16 v[36:37], v29 offset:16384
    ds_read_b64_tr_b16 v[38:39], v29 offset:17408
    ds_read_b64_tr_b16 v[40:41], v30 offset:16384
    ds_read_b64_tr_b16 v[42:43], v30 offset:17408
    ds_read_b64_tr_b16 v[44:45], v31 offset:16384
    ds_read_b64_tr_b16 v[46:47], v31 offset:17408
    ds_read_b64_tr_b16 v[48:49], v28 offset:20480
    ds_read_b64_tr_b16 v[50:51], v28 offset:21504
    s_waitcnt lgkmcnt(8)
    v_mfma_f32_32x32x16_bf16 v[64:79], v[32:35], v[176:179], v[64:79]
    ds_read_b64_tr_b16 v[52:53], v29 offset:20480
    ds_read_b64_tr_b16 v[54:55], v29 offset:21504
    s_add_u32 s42, s51, 4
    s_and_b32 s42, s42, 7
    s_lshl_b32 s42, s42, 19
    s_add_u32 s41, s46, s42
    s_add_u32 m0, s50, 0x20000
    s_nop 0
    buffer_load_dwordx4 v13, s[16:19], s41 offen offset:0 lds
    s_waitcnt lgkmcnt(8)
    v_mfma_f32_32x32x16_bf16 v[80:95], v[36:39], v[176:179], v[80:95]
    ds_read_b64_tr_b16 v[56:57], v30 offset:20480
    ds_read_b64_tr_b16 v[58:59], v30 offset:21504
    s_add_u32 s41, s41, 0x7c00
    buffer_load_dwordx4 v13, s[16:19], s41 offen offset:1024 lds
    s_add_u32 s41, s41, 0x7c00
    buffer_load_dwordx4 v13, s[16:19], s41 offen offset:2048 lds
    s_waitcnt lgkmcnt(8)
    v_mfma_f32_32x32x16_bf16 v[96:111], v[40:43], v[176:179], v[96:111]
    ds_read_b64_tr_b16 v[60:61], v31 offset:20480
    ds_read_b64_tr_b16 v[62:63], v31 offset:21504
    s_add_u32 s41, s41, 0x7c00
    buffer_load_dwordx4 v13, s[16:19], s41 offen offset:3072 lds
    s_waitcnt lgkmcnt(8)
    v_mfma_f32_32x32x16_bf16 v[112:127], v[44:47], v[176:179], v[112:127]
    ds_read_b64_tr_b16 v[32:33], v28 offset:24576
    ds_read_b64_tr_b16 v[34:35], v28 offset:25600
    s_add_u32 s42, s6, 5
    s_and_b32 s42, s42, 7
    s_lshl_b32 s42, s42, 14
    s_add_u32 s41, s39, s42
    s_add_u32 m0, s50, 0x8000
    s_nop 0
    buffer_load_dwordx4 v8, s[8:11], s41 offen offset:0 nt lds
    buffer_load_dwordx4 v9, s[8:11], s41 offen offset:1024 nt lds
    s_waitcnt lgkmcnt(8)
    v_mfma_f32_32x32x16_bf16 v[64:79], v[48:51], v[180:183], v[64:79]
    ds_read_b64_tr_b16 v[36:37], v29 offset:24576
    ds_read_b64_tr_b16 v[38:39], v29 offset:25600
    buffer_load_dwordx4 v10, s[8:11], s41 offen offset:2048 nt lds
    s_waitcnt lgkmcnt(8)
    v_mfma_f32_32x32x16_bf16 v[80:95], v[52:55], v[180:183], v[80:95]
    ds_read_b64_tr_b16 v[40:41], v30 offset:24576
    ds_read_b64_tr_b16 v[42:43], v30 offset:25600
    buffer_load_dwordx4 v11, s[8:11], s41 offen offset:3072 nt lds
    s_add_u32 s42, s6, 4
    s_and_b32 s42, s42, 7
    s_lshl_b32 s42, s42, 14
    s_add_u32 s41, s39, s42
    s_add_u32 m0, s50, 0x10000
    s_nop 0
    buffer_load_dwordx4 v12, s[12:15], s41 offen offset:0 nt lds
    s_waitcnt lgkmcnt(8)
    v_mfma_f32_32x32x16_bf16 v[96:111], v[56:59], v[180:183], v[96:111]
    ds_read_b64_tr_b16 v[44:45], v31 offset:24576
    ds_read_b64_tr_b16 v[46:47], v31 offset:25600
    buffer_load_dwordx4 v12, s[12:15], s41 offen offset:1024 nt lds
    s_waitcnt lgkmcnt(8)
    v_mfma_f32_32x32x16_bf16 v[112:127], v[60:63], v[180:183], v[112:127]
    ds_read_b64_tr_b16 v[48:49], v28 offset:28672
    ds_read_b64_tr_b16 v[50:51], v28 offset:29696
    buffer_load_dwordx4 v12, s[12:15], s41 offen offset:2048 nt lds
    buffer_load_dwordx4 v12, s[12:15], s41 offen offset:3072 nt lds
    s_waitcnt lgkmcnt(8)
    v_mfma_f32_32x32x16_bf16 v[64:79], v[32:35], v[184:187], v[64:79]
    ds_read_b64_tr_b16 v[52:53], v29 offset:28672
    ds_read_b64_tr_b16 v[54:55], v29 offset:29696
    s_waitcnt lgkmcnt(8)
    v_mfma_f32_32x32x16_bf16 v[80:95], v[36:39], v[184:187], v[80:95]
    ds_read_b64_tr_b16 v[56:57], v30 offset:28672
    ds_read_b64_tr_b16 v[58:59], v30 offset:29696
    s_waitcnt lgkmcnt(8)
    v_mfma_f32_32x32x16_bf16 v[96:111], v[40:43], v[184:187], v[96:111]
    ds_read_b64_tr_b16 v[60:61], v31 offset:28672
    ds_read_b64_tr_b16 v[62:63], v31 offset:29696
    s_waitcnt lgkmcnt(8)
    v_mfma_f32_32x32x16_bf16 v[112:127], v[44:47], v[184:187], v[112:127]
    s_waitcnt lgkmcnt(6)
    v_mfma_f32_32x32x16_bf16 v[64:79], v[48:51], v[188:191], v[64:79]
    s_waitcnt lgkmcnt(4)
    v_mfma_f32_32x32x16_bf16 v[80:95], v[52:55], v[188:191], v[80:95]
    s_waitcnt lgkmcnt(2)
    v_mfma_f32_32x32x16_bf16 v[96:111], v[56:59], v[188:191], v[96:111]
    s_waitcnt lgkmcnt(0)
    v_mfma_f32_32x32x16_bf16 v[112:127], v[60:63], v[188:191], v[112:127]
    s_waitcnt vmcnt(8) lgkmcnt(0)
    s_barrier
    ds_read_b64_tr_b16 v[32:33], v28 offset:0
    ds_read_b64_tr_b16 v[34:35], v28 offset:1024
    ds_read_b64_tr_b16 v[36:37], v29 offset:0
    ds_read_b64_tr_b16 v[38:39], v29 offset:1024
    ds_read_b64_tr_b16 v[40:41], v30 offset:0
    ds_read_b64_tr_b16 v[42:43], v30 offset:1024
    ds_read_b64_tr_b16 v[44:45], v31 offset:0
    ds_read_b64_tr_b16 v[46:47], v31 offset:1024
    ds_read_b64_tr_b16 v[48:49], v28 offset:4096
    ds_read_b64_tr_b16 v[50:51], v28 offset:5120
    s_waitcnt lgkmcnt(8)
    v_mfma_f32_32x32x16_bf16 v[64:79], v[32:35], v[192:195], v[64:79]
    ds_read_b64_tr_b16 v[52:53], v29 offset:4096
    ds_read_b64_tr_b16 v[54:55], v29 offset:5120
    s_add_u32 s42, s51, 5
    s_and_b32 s42, s42, 7
    s_lshl_b32 s42, s42, 19
    s_add_u32 s41, s46, s42
    s_add_u32 m0, s50, 0x24000
    s_nop 0
    buffer_load_dwordx4 v13, s[16:19], s41 offen offset:0 lds
    s_waitcnt lgkmcnt(8)
    v_mfma_f32_32x32x16_bf16 v[80:95], v[36:39], v[192:195], v[80:95]
    ds_read_b64_tr_b16 v[56:57], v30 offset:4096
    ds_read_b64_tr_b16 v[58:59], v30 offset:5120
    s_add_u32 s41, s41, 0x7c00
    buffer_load_dwordx4 v13, s[16:19], s41 offen offset:1024 lds
    s_add_u32 s41, s41, 0x7c00
    buffer_load_dwordx4 v13, s[16:19], s41 offen offset:2048 lds
    s_waitcnt lgkmcnt(8)
    v_mfma_f32_32x32x16_bf16 v[96:111], v[40:43], v[192:195], v[96:111]
    ds_read_b64_tr_b16 v[60:61], v31 offset:4096
    ds_read_b64_tr_b16 v[62:63], v31 offset:5120
    s_add_u32 s41, s41, 0x7c00
    buffer_load_dwordx4 v13, s[16:19], s41 offen offset:3072 lds
    s_waitcnt lgkmcnt(8)
    v_mfma_f32_32x32x16_bf16 v[112:127], v[44:47], v[192:195], v[112:127]
    ds_read_b64_tr_b16 v[32:33], v28 offset:8192
    ds_read_b64_tr_b16 v[34:35], v28 offset:9216
    s_add_u32 s42, s6, 6
    s_and_b32 s42, s42, 7
    s_lshl_b32 s42, s42, 14
    s_add_u32 s41, s39, s42
    s_add_u32 m0, s50, 0x0
    s_nop 0
    buffer_load_dwordx4 v8, s[8:11], s41 offen offset:0 nt lds
    buffer_load_dwordx4 v9, s[8:11], s41 offen offset:1024 nt lds
    s_waitcnt lgkmcnt(8)
    v_mfma_f32_32x32x16_bf16 v[64:79], v[48:51], v[196:199], v[64:79]
    ds_read_b64_tr_b16 v[36:37], v29 offset:8192
    ds_read_b64_tr_b16 v[38:39], v29 offset:9216
    buffer_load_dwordx4 v10, s[8:11], s41 offen offset:2048 nt lds
    s_waitcnt lgkmcnt(8)
    v_mfma_f32_32x32x16_bf16 v[80:95], v[52:55], v[196:199], v[80:95]
    ds_read_b64_tr_b16 v[40:41], v30 offset:8192
    ds_read_b64_tr_b16 v[42:43], v30 offset:9216
    buffer_load_dwordx4 v11, s[8:11], s41 offen offset:3072 nt lds
    s_add_u32 s42, s6, 5
    s_and_b32 s42, s42, 7
    s_lshl_b32 s42, s42, 14
    s_add_u32 s41, s39, s42
    s_add_u32 m0, s50, 0x14000
    s_nop 0
    buffer_load_dwordx4 v12, s[12:15], s41 offen offset:0 nt lds
    s_waitcnt lgkmcnt(8)
    v_mfma_f32_32x32x16_bf16 v[96:111], v[56:59], v[196:199], v[96:111]
    ds_read_b64_tr_b16 v[44:45], v31 offset:8192
    ds_read_b64_tr_b16 v[46:47], v31 offset:9216
    buffer_load_dwordx4 v12, s[12:15], s41 offen offset:1024 nt lds
    s_waitcnt lgkmcnt(8)
    v_mfma_f32_32x32x16_bf16 v[112:127], v[60:63], v[196:199], v[112:127]
    ds_read_b64_tr_b16 v[48:49], v28 offset:12288
    ds_read_b64_tr_b16 v[50:51], v28 offset:13312
    buffer_load_dwordx4 v12, s[12:15], s41 offen offset:2048 nt lds
    buffer_load_dwordx4 v12, s[12:15], s41 offen offset:3072 nt lds
    s_waitcnt lgkmcnt(8)
    v_mfma_f32_32x32x16_bf16 v[64:79], v[32:35], v[200:203], v[64:79]
    ds_read_b64_tr_b16 v[52:53], v29 offset:12288
    ds_read_b64_tr_b16 v[54:55], v29 offset:13312
    s_waitcnt lgkmcnt(8)
    v_mfma_f32_32x32x16_bf16 v[80:95], v[36:39], v[200:203], v[80:95]
    ds_read_b64_tr_b16 v[56:57], v30 offset:12288
    ds_read_b64_tr_b16 v[58:59], v30 offset:13312
    s_waitcnt lgkmcnt(8)
    v_mfma_f32_32x32x16_bf16 v[96:111], v[40:43], v[200:203], v[96:111]
    ds_read_b64_tr_b16 v[60:61], v31 offset:12288
    ds_read_b64_tr_b16 v[62:63], v31 offset:13312
    s_waitcnt lgkmcnt(8)
    v_mfma_f32_32x32x16_bf16 v[112:127], v[44:47], v[200:203], v[112:127]
    s_waitcnt lgkmcnt(6)
    v_mfma_f32_32x32x16_bf16 v[64:79], v[48:51], v[204:207], v[64:79]
    s_waitcnt lgkmcnt(4)
    v_mfma_f32_32x32x16_bf16 v[80:95], v[52:55], v[204:207], v[80:95]
    s_waitcnt lgkmcnt(2)
    v_mfma_f32_32x32x16_bf16 v[96:111], v[56:59], v[204:207], v[96:111]
    s_waitcnt lgkmcnt(0)
    v_mfma_f32_32x32x16_bf16 v[112:127], v[60:63], v[204:207], v[112:127]
    s_waitcnt vmcnt(8) lgkmcnt(0)
    s_barrier
    ds_read_b64_tr_b16 v[32:33], v28 offset:16384
    ds_read_b64_tr_b16 v[34:35], v28 offset:17408
    ds_read_b64_tr_b16 v[36:37], v29 offset:16384
    ds_read_b64_tr_b16 v[38:39], v29 offset:17408
    ds_read_b64_tr_b16 v[40:41], v30 offset:16384
    ds_read_b64_tr_b16 v[42:43], v30 offset:17408
    ds_read_b64_tr_b16 v[44:45], v31 offset:16384
    ds_read_b64_tr_b16 v[46:47], v31 offset:17408
    ds_read_b64_tr_b16 v[48:49], v28 offset:20480
    ds_read_b64_tr_b16 v[50:51], v28 offset:21504
    s_waitcnt lgkmcnt(8)
    v_mfma_f32_32x32x16_bf16 v[64:79], v[32:35], v[208:211], v[64:79]
    ds_read_b64_tr_b16 v[52:53], v29 offset:20480
    ds_read_b64_tr_b16 v[54:55], v29 offset:21504
    s_add_u32 s42, s51, 6
    s_and_b32 s42, s42, 7
    s_lshl_b32 s42, s42, 19
    s_add_u32 s41, s46, s42
    s_add_u32 m0, s50, 0x20000
    s_nop 0
    buffer_load_dwordx4 v13, s[16:19], s41 offen offset:0 lds
    s_waitcnt lgkmcnt(8)
    v_mfma_f32_32x32x16_bf16 v[80:95], v[36:39], v[208:211], v[80:95]
    ds_read_b64_tr_b16 v[56:57], v30 offset:20480
    ds_read_b64_tr_b16 v[58:59], v30 offset:21504
    s_add_u32 s41, s41, 0x7c00
    buffer_load_dwordx4 v13, s[16:19], s41 offen offset:1024 lds
    s_add_u32 s41, s41, 0x7c00
    buffer_load_dwordx4 v13, s[16:19], s41 offen offset:2048 lds
    s_waitcnt lgkmcnt(8)
    v_mfma_f32_32x32x16_bf16 v[96:111], v[40:43], v[208:211], v[96:111]
    ds_read_b64_tr_b16 v[60:61], v31 offset:20480
    ds_read_b64_tr_b16 v[62:63], v31 offset:21504
    s_add_u32 s41, s41, 0x7c00
    buffer_load_dwordx4 v13, s[16:19], s41 offen offset:3072 lds
    s_waitcnt lgkmcnt(8)
    v_mfma_f32_32x32x16_bf16 v[112:127], v[44:47], v[208:211], v[112:127]
    ds_read_b64_tr_b16 v[32:33], v28 offset:24576
    ds_read_b64_tr_b16 v[34:35], v28 offset:25600
    s_add_u32 s42, s6, 7
    s_and_b32 s42, s42, 7
    s_lshl_b32 s42, s42, 14
    s_add_u32 s41, s39, s42
    s_add_u32 m0, s50, 0x4000
    s_nop 0
    buffer_load_dwordx4 v8, s[8:11], s41 offen offset:0 nt lds
    buffer_load_dwordx4 v9, s[8:11], s41 offen offset:1024 nt lds
    s_waitcnt lgkmcnt(8)
    v_mfma_f32_32x32x16_bf16 v[64:79], v[48:51], v[212:215], v[64:79]
    ds_read_b64_tr_b16 v[36:37], v29 offset:24576
    ds_read_b64_tr_b16 v[38:39], v29 offset:25600
    buffer_load_dwordx4 v10, s[8:11], s41 offen offset:2048 nt lds
    s_waitcnt lgkmcnt(8)
    v_mfma_f32_32x32x16_bf16 v[80:95], v[52:55], v[212:215], v[80:95]
    ds_read_b64_tr_b16 v[40:41], v30 offset:24576
    ds_read_b64_tr_b16 v[42:43], v30 offset:25600
    buffer_load_dwordx4 v11, s[8:11], s41 offen offset:3072 nt lds
    s_add_u32 s42, s6, 6
    s_and_b32 s42, s42, 7
    s_lshl_b32 s42, s42, 14
    s_add_u32 s41, s39, s42
    s_add_u32 m0, s50, 0xc000
    s_nop 0
    buffer_load_dwordx4 v12, s[12:15], s41 offen offset:0 nt lds
    s_waitcnt lgkmcnt(8)
    v_mfma_f32_32x32x16_bf16 v[96:111], v[56:59], v[212:215], v[96:111]
    ds_read_b64_tr_b16 v[44:45], v31 offset:24576
    ds_read_b64_tr_b16 v[46:47], v31 offset:25600
    buffer_load_dwordx4 v12, s[12:15], s41 offen offset:1024 nt lds
    s_waitcnt lgkmcnt(8)
    v_mfma_f32_32x32x16_bf16 v[112:127], v[60:63], v[212:215], v[112:127]
    ds_read_b64_tr_b16 v[48:49], v28 offset:28672
    ds_read_b64_tr_b16 v[50:51], v28 offset:29696
    buffer_load_dwordx4 v12, s[12:15], s41 offen offset:2048 nt lds
    buffer_load_dwordx4 v12, s[12:15], s41 offen offset:3072 nt lds
    s_waitcnt lgkmcnt(8)
    v_mfma_f32_32x32x16_bf16 v[64:79], v[32:35], v[216:219], v[64:79]
    ds_read_b64_tr_b16 v[52:53], v29 offset:28672
    ds_read_b64_tr_b16 v[54:55], v29 offset:29696
    s_waitcnt lgkmcnt(8)
    v_mfma_f32_32x32x16_bf16 v[80:95], v[36:39], v[216:219], v[80:95]
    ds_read_b64_tr_b16 v[56:57], v30 offset:28672
    ds_read_b64_tr_b16 v[58:59], v30 offset:29696
    s_waitcnt lgkmcnt(8)
    v_mfma_f32_32x32x16_bf16 v[96:111], v[40:43], v[216:219], v[96:111]
    ds_read_b64_tr_b16 v[60:61], v31 offset:28672
    ds_read_b64_tr_b16 v[62:63], v31 offset:29696
    s_waitcnt lgkmcnt(8)
    v_mfma_f32_32x32x16_bf16 v[112:127], v[44:47], v[216:219], v[112:127]
    s_waitcnt lgkmcnt(6)
    v_mfma_f32_32x32x16_bf16 v[64:79], v[48:51], v[220:223], v[64:79]
    s_waitcnt lgkmcnt(4)
    v_mfma_f32_32x32x16_bf16 v[80:95], v[52:55], v[220:223], v[80:95]
    s_waitcnt lgkmcnt(2)
    v_mfma_f32_32x32x16_bf16 v[96:111], v[56:59], v[220:223], v[96:111]
    s_waitcnt lgkmcnt(0)
    v_mfma_f32_32x32x16_bf16 v[112:127], v[60:63], v[220:223], v[112:127]
    s_waitcnt vmcnt(8) lgkmcnt(0)
    s_barrier
    ds_read_b64_tr_b16 v[32:33], v28 offset:0
    ds_read_b64_tr_b16 v[34:35], v28 offset:1024
    ds_read_b64_tr_b16 v[36:37], v29 offset:0
    ds_read_b64_tr_b16 v[38:39], v29 offset:1024
    ds_read_b64_tr_b16 v[40:41], v30 offset:0
    ds_read_b64_tr_b16 v[42:43], v30 offset:1024
    ds_read_b64_tr_b16 v[44:45], v31 offset:0
    ds_read_b64_tr_b16 v[46:47], v31 offset:1024
    ds_read_b64_tr_b16 v[48:49], v28 offset:4096
    ds_read_b64_tr_b16 v[50:51], v28 offset:5120
    s_waitcnt lgkmcnt(8)
    v_mfma_f32_32x32x16_bf16 v[64:79], v[32:35], v[224:227], v[64:79]
    ds_read_b64_tr_b16 v[52:53], v29 offset:4096
    ds_read_b64_tr_b16 v[54:55], v29 offset:5120
    s_add_u32 s42, s51, 7
    s_and_b32 s42, s42, 7
    s_lshl_b32 s42, s42, 19
    s_add_u32 s41, s46, s42
    s_add_u32 m0, s50, 0x24000
    s_nop 0
    buffer_load_dwordx4 v13, s[16:19], s41 offen offset:0 lds
    s_waitcnt lgkmcnt(8)
    v_mfma_f32_32x32x16_bf16 v[80:95], v[36:39], v[224:227], v[80:95]
    ds_read_b64_tr_b16 v[56:57], v30 offset:4096
    ds_read_b64_tr_b16 v[58:59], v30 offset:5120
    s_add_u32 s41, s41, 0x7c00
    buffer_load_dwordx4 v13, s[16:19], s41 offen offset:1024 lds
    s_add_u32 s41, s41, 0x7c00
    buffer_load_dwordx4 v13, s[16:19], s41 offen offset:2048 lds
    s_waitcnt lgkmcnt(8)
    v_mfma_f32_32x32x16_bf16 v[96:111], v[40:43], v[224:227], v[96:111]
    ds_read_b64_tr_b16 v[60:61], v31 offset:4096
    ds_read_b64_tr_b16 v[62:63], v31 offset:5120
    s_add_u32 s41, s41, 0x7c00
    buffer_load_dwordx4 v13, s[16:19], s41 offen offset:3072 lds
    s_waitcnt lgkmcnt(8)
    v_mfma_f32_32x32x16_bf16 v[112:127], v[44:47], v[224:227], v[112:127]
    ds_read_b64_tr_b16 v[32:33], v28 offset:8192
    ds_read_b64_tr_b16 v[34:35], v28 offset:9216
    s_add_u32 s42, s6, 0
    s_and_b32 s42, s42, 7
    s_lshl_b32 s42, s42, 14
    s_add_u32 s41, s40, s42
    s_add_u32 m0, s50, 0x8000
    s_nop 0
    buffer_load_dwordx4 v8, s[8:11], s41 offen offset:0 nt lds
    buffer_load_dwordx4 v9, s[8:11], s41 offen offset:1024 nt lds
    s_waitcnt lgkmcnt(8)
    v_mfma_f32_32x32x16_bf16 v[64:79], v[48:51], v[228:231], v[64:79]
    ds_read_b64_tr_b16 v[36:37], v29 offset:8192
    ds_read_b64_tr_b16 v[38:39], v29 offset:9216
    buffer_load_dwordx4 v10, s[8:11], s41 offen offset:2048 nt lds
    s_waitcnt lgkmcnt(8)
    v_mfma_f32_32x32x16_bf16 v[80:95], v[52:55], v[228:231], v[80:95]
    ds_read_b64_tr_b16 v[40:41], v30 offset:8192
    ds_read_b64_tr_b16 v[42:43], v30 offset:9216
    buffer_load_dwordx4 v11, s[8:11], s41 offen offset:3072 nt lds
    s_add_u32 s42, s6, 7
    s_and_b32 s42, s42, 7
    s_lshl_b32 s42, s42, 14
    s_add_u32 s41, s39, s42
    s_add_u32 m0, s50, 0x10000
    s_nop 0
    buffer_load_dwordx4 v12, s[12:15], s41 offen offset:0 nt lds
    s_waitcnt lgkmcnt(8)
    v_mfma_f32_32x32x16_bf16 v[96:111], v[56:59], v[228:231], v[96:111]
    ds_read_b64_tr_b16 v[44:45], v31 offset:8192
    ds_read_b64_tr_b16 v[46:47], v31 offset:9216
    buffer_load_dwordx4 v12, s[12:15], s41 offen offset:1024 nt lds
    s_waitcnt lgkmcnt(8)
    v_mfma_f32_32x32x16_bf16 v[112:127], v[60:63], v[228:231], v[112:127]
    ds_read_b64_tr_b16 v[48:49], v28 offset:12288
    ds_read_b64_tr_b16 v[50:51], v28 offset:13312
    buffer_load_dwordx4 v12, s[12:15], s41 offen offset:2048 nt lds
    buffer_load_dwordx4 v12, s[12:15], s41 offen offset:3072 nt lds
    s_waitcnt lgkmcnt(8)
    v_mfma_f32_32x32x16_bf16 v[64:79], v[32:35], v[232:235], v[64:79]
    ds_read_b64_tr_b16 v[52:53], v29 offset:12288
    ds_read_b64_tr_b16 v[54:55], v29 offset:13312
    s_waitcnt lgkmcnt(8)
    v_mfma_f32_32x32x16_bf16 v[80:95], v[36:39], v[232:235], v[80:95]
    ds_read_b64_tr_b16 v[56:57], v30 offset:12288
    ds_read_b64_tr_b16 v[58:59], v30 offset:13312
    s_waitcnt lgkmcnt(8)
    v_mfma_f32_32x32x16_bf16 v[96:111], v[40:43], v[232:235], v[96:111]
    ds_read_b64_tr_b16 v[60:61], v31 offset:12288
    ds_read_b64_tr_b16 v[62:63], v31 offset:13312
    s_waitcnt lgkmcnt(8)
    v_mfma_f32_32x32x16_bf16 v[112:127], v[44:47], v[232:235], v[112:127]
    s_waitcnt lgkmcnt(6)
    v_mfma_f32_32x32x16_bf16 v[64:79], v[48:51], v[236:239], v[64:79]
    s_waitcnt lgkmcnt(4)
    v_mfma_f32_32x32x16_bf16 v[80:95], v[52:55], v[236:239], v[80:95]
    s_waitcnt lgkmcnt(2)
    v_mfma_f32_32x32x16_bf16 v[96:111], v[56:59], v[236:239], v[96:111]
    s_waitcnt lgkmcnt(0)
    v_mfma_f32_32x32x16_bf16 v[112:127], v[60:63], v[236:239], v[112:127]
    s_waitcnt vmcnt(8) lgkmcnt(0)
    s_barrier
    ds_read_b64_tr_b16 v[32:33], v28 offset:16384
    ds_read_b64_tr_b16 v[34:35], v28 offset:17408
    ds_read_b64_tr_b16 v[36:37], v28 offset:20480
    ds_read_b64_tr_b16 v[38:39], v28 offset:21504
    ds_read_b64_tr_b16 v[40:41], v28 offset:24576
    ds_read_b64_tr_b16 v[42:43], v28 offset:25600
    ds_read_b64_tr_b16 v[44:45], v28 offset:28672
    ds_read_b64_tr_b16 v[46:47], v28 offset:29696
    ds_read_b64_tr_b16 v[48:49], v29 offset:16384
    ds_read_b64_tr_b16 v[50:51], v29 offset:17408
    s_waitcnt lgkmcnt(8)
    v_mfma_f32_32x32x16_bf16 v[64:79], v[32:35], v[240:243], v[64:79]
    ds_read_b64_tr_b16 v[52:53], v29 offset:20480
    ds_read_b64_tr_b16 v[54:55], v29 offset:21504
    s_add_u32 s42, s6, 1
    s_and_b32 s42, s42, 7
    s_lshl_b32 s42, s42, 14
    s_add_u32 s41, s40, s42
    s_add_u32 m0, s50, 0x0
    s_nop 0
    buffer_load_dwordx4 v8, s[8:11], s41 offen offset:0 nt lds
    s_waitcnt lgkmcnt(8)
    v_mfma_f32_32x32x16_bf16 v[64:79], v[36:39], v[244:247], v[64:79]
    ds_read_b64_tr_b16 v[56:57], v29 offset:24576
    ds_read_b64_tr_b16 v[58:59], v29 offset:25600
    buffer_load_dwordx4 v9, s[8:11], s41 offen offset:1024 nt lds
    s_waitcnt lgkmcnt(8)
    v_mfma_f32_32x32x16_bf16 v[64:79], v[40:43], v[248:251], v[64:79]
    ds_read_b64_tr_b16 v[60:61], v29 offset:28672
    ds_read_b64_tr_b16 v[62:63], v29 offset:29696
    buffer_load_dwordx4 v10, s[8:11], s41 offen offset:2048 nt lds
    s_waitcnt lgkmcnt(8)
    v_mfma_f32_32x32x16_bf16 v[64:79], v[44:47], v[252:255], v[64:79]
    ds_read_b64_tr_b16 v[32:33], v30 offset:16384
    ds_read_b64_tr_b16 v[34:35], v30 offset:17408
    buffer_load_dwordx4 v11, s[8:11], s41 offen offset:3072 nt lds
    s_waitcnt lgkmcnt(8)
    v_mfma_f32_32x32x16_bf16 v[80:95], v[48:51], v[240:243], v[80:95]
    ds_read_b64_tr_b16 v[36:37], v30 offset:20480
    ds_read_b64_tr_b16 v[38:39], v30 offset:21504
    s_add_u32 s42, s6, 0
    s_and_b32 s42, s42, 7
    s_lshl_b32 s42, s42, 14
    s_add_u32 s41, s40, s42
    s_add_u32 m0, s50, 0x14000
    s_nop 0
    buffer_load_dwordx4 v12, s[12:15], s41 offen offset:0 nt lds
    s_waitcnt lgkmcnt(8)
    v_mfma_f32_32x32x16_bf16 v[80:95], v[52:55], v[244:247], v[80:95]
    ds_read_b64_tr_b16 v[40:41], v30 offset:24576
    ds_read_b64_tr_b16 v[42:43], v30 offset:25600
    buffer_load_dwordx4 v12, s[12:15], s41 offen offset:1024 nt lds
    s_waitcnt lgkmcnt(8)
    v_mfma_f32_32x32x16_bf16 v[80:95], v[56:59], v[248:251], v[80:95]
    ds_read_b64_tr_b16 v[44:45], v30 offset:28672
    ds_read_b64_tr_b16 v[46:47], v30 offset:29696
    buffer_load_dwordx4 v12, s[12:15], s41 offen offset:2048 nt lds
    s_waitcnt lgkmcnt(8)
    v_mfma_f32_32x32x16_bf16 v[80:95], v[60:63], v[252:255], v[80:95]
    ds_read_b64_tr_b16 v[48:49], v31 offset:16384
    ds_read_b64_tr_b16 v[50:51], v31 offset:17408
    buffer_load_dwordx4 v12, s[12:15], s41 offen offset:3072 nt lds
    s_waitcnt lgkmcnt(8)
    v_mfma_f32_32x32x16_bf16 v[96:111], v[32:35], v[240:243], v[96:111]
    ds_read_b64_tr_b16 v[52:53], v31 offset:20480
    ds_read_b64_tr_b16 v[54:55], v31 offset:21504
    v_mul_f32 v64, s44, v64
    v_mul_f32 v65, s44, v65
    v_mul_f32 v66, s44, v66
    v_mul_f32 v67, s44, v67
    v_mul_f32 v68, s44, v68
    v_mul_f32 v69, s44, v69
    v_mul_f32 v70, s44, v70
    v_mul_f32 v71, s44, v71
    v_mul_f32 v72, s44, v72
    v_mul_f32 v73, s44, v73
    v_mul_f32 v74, s44, v74
    v_mul_f32 v75, s44, v75
    v_mul_f32 v76, s44, v76
    v_mul_f32 v77, s44, v77
    v_mul_f32 v78, s44, v78
    v_mul_f32 v79, s44, v79
    v_cvt_pk_bf16_f32 v64, v64, v65
    v_cvt_pk_bf16_f32 v65, v66, v67
    v_cvt_pk_bf16_f32 v66, v68, v69
    v_cvt_pk_bf16_f32 v67, v70, v71
    v_cvt_pk_bf16_f32 v68, v72, v73
    v_cvt_pk_bf16_f32 v69, v74, v75
    v_cvt_pk_bf16_f32 v70, v76, v77
    v_cvt_pk_bf16_f32 v71, v78, v79
    ds_write_b128 v14, v[64:67] offset:0
    ds_write_b128 v14, v[68:71] offset:1024
    s_waitcnt lgkmcnt(10)
    v_mfma_f32_32x32x16_bf16 v[96:111], v[36:39], v[244:247], v[96:111]
    ds_read_b64_tr_b16 v[56:57], v31 offset:24576
    ds_read_b64_tr_b16 v[58:59], v31 offset:25600
    s_waitcnt lgkmcnt(10)
    v_mfma_f32_32x32x16_bf16 v[96:111], v[40:43], v[248:251], v[96:111]
    ds_read_b64_tr_b16 v[60:61], v31 offset:28672
    ds_read_b64_tr_b16 v[62:63], v31 offset:29696
    s_waitcnt lgkmcnt(10)
    v_mfma_f32_32x32x16_bf16 v[96:111], v[44:47], v[252:255], v[96:111]
    v_mul_f32 v80, s44, v80
    v_mul_f32 v81, s44, v81
    v_mul_f32 v82, s44, v82
    v_mul_f32 v83, s44, v83
    v_mul_f32 v84, s44, v84
    v_mul_f32 v85, s44, v85
    v_mul_f32 v86, s44, v86
    v_mul_f32 v87, s44, v87
    v_mul_f32 v88, s44, v88
    v_mul_f32 v89, s44, v89
    v_mul_f32 v90, s44, v90
    v_mul_f32 v91, s44, v91
    v_mul_f32 v92, s44, v92
    v_mul_f32 v93, s44, v93
    v_mul_f32 v94, s44, v94
    v_mul_f32 v95, s44, v95
    v_cvt_pk_bf16_f32 v80, v80, v81
    v_cvt_pk_bf16_f32 v81, v82, v83
    v_cvt_pk_bf16_f32 v82, v84, v85
    v_cvt_pk_bf16_f32 v83, v86, v87
    v_cvt_pk_bf16_f32 v84, v88, v89
    v_cvt_pk_bf16_f32 v85, v90, v91
    v_cvt_pk_bf16_f32 v86, v92, v93
    v_cvt_pk_bf16_f32 v87, v94, v95
    ds_write_b128 v14, v[80:83] offset:2048
    ds_write_b128 v14, v[84:87] offset:3072
    s_waitcnt lgkmcnt(10)
    v_mfma_f32_32x32x16_bf16 v[112:127], v[48:51], v[240:243], v[112:127]
    s_waitcnt lgkmcnt(8)
    v_mfma_f32_32x32x16_bf16 v[112:127], v[52:55], v[244:247], v[112:127]
    s_waitcnt lgkmcnt(4)
    v_mfma_f32_32x32x16_bf16 v[112:127], v[56:59], v[248:251], v[112:127]
    s_waitcnt lgkmcnt(2)
    v_mfma_f32_32x32x16_bf16 v[112:127], v[60:63], v[252:255], v[112:127]
    v_mul_f32 v96, s44, v96
    v_mul_f32 v97, s44, v97
    v_mul_f32 v98, s44, v98
    v_mul_f32 v99, s44, v99
    v_mul_f32 v100, s44, v100
    v_mul_f32 v101, s44, v101
    v_mul_f32 v102, s44, v102
    v_mul_f32 v103, s44, v103
    v_mul_f32 v104, s44, v104
    v_mul_f32 v105, s44, v105
    v_mul_f32 v106, s44, v106
    v_mul_f32 v107, s44, v107
    v_mul_f32 v108, s44, v108
    v_mul_f32 v109, s44, v109
    v_mul_f32 v110, s44, v110
    v_mul_f32 v111, s44, v111
    v_cvt_pk_bf16_f32 v96, v96, v97
    v_cvt_pk_bf16_f32 v97, v98, v99
    v_cvt_pk_bf16_f32 v98, v100, v101
    v_cvt_pk_bf16_f32 v99, v102, v103
    v_cvt_pk_bf16_f32 v100, v104, v105
    v_cvt_pk_bf16_f32 v101, v106, v107
    v_cvt_pk_bf16_f32 v102, v108, v109
    v_cvt_pk_bf16_f32 v103, v110, v111
    ds_write_b128 v14, v[96:99] offset:4096
    ds_write_b128 v14, v[100:103] offset:5120
    v_mul_f32 v112, s44, v112
    v_mul_f32 v113, s44, v113
    v_mul_f32 v114, s44, v114
    v_mul_f32 v115, s44, v115
    v_mul_f32 v116, s44, v116
    v_mul_f32 v117, s44, v117
    v_mul_f32 v118, s44, v118
    v_mul_f32 v119, s44, v119
    v_mul_f32 v120, s44, v120
    v_mul_f32 v121, s44, v121
    v_mul_f32 v122, s44, v122
    v_mul_f32 v123, s44, v123
    v_mul_f32 v124, s44, v124
    v_mul_f32 v125, s44, v125
    v_mul_f32 v126, s44, v126
    v_mul_f32 v127, s44, v127
    v_cvt_pk_bf16_f32 v112, v112, v113
    v_cvt_pk_bf16_f32 v113, v114, v115
    v_cvt_pk_bf16_f32 v114, v116, v117
    v_cvt_pk_bf16_f32 v115, v118, v119
    v_cvt_pk_bf16_f32 v116, v120, v121
    v_cvt_pk_bf16_f32 v117, v122, v123
    v_cvt_pk_bf16_f32 v118, v124, v125
    v_cvt_pk_bf16_f32 v119, v126, v127
    ds_write_b128 v14, v[112:115] offset:6144
    ds_write_b128 v14, v[116:119] offset:7168
    s_waitcnt vmcnt(8) lgkmcnt(0)
    s_barrier
    s_lshl_b32 s41, s85, 6
    v_xor_b32 v28, s41, v28
    v_xor_b32 v29, s41, v29
    v_xor_b32 v30, s41, v30
    v_xor_b32 v31, s41, v31
    s_add_u32 s42, s6, 2
    s_and_b32 s42, s42, 7
    s_lshl_b32 s42, s42, 14
    s_add_u32 s41, s40, s42
    s_add_u32 m0, s50, 0x4000
    s_nop 0
    buffer_load_dwordx4 v8, s[8:11], s41 offen offset:0 nt lds
    buffer_load_dwordx4 v9, s[8:11], s41 offen offset:1024 nt lds
    buffer_load_dwordx4 v10, s[8:11], s41 offen offset:2048 nt lds
    buffer_load_dwordx4 v11, s[8:11], s41 offen offset:3072 nt lds
    s_add_u32 s42, s6, 1
    s_and_b32 s42, s42, 7
    s_lshl_b32 s42, s42, 14
    s_add_u32 s41, s40, s42
    s_add_u32 m0, s50, 0xc000
    s_nop 0
    buffer_load_dwordx4 v12, s[12:15], s41 offen offset:0 nt lds
    buffer_load_dwordx4 v12, s[12:15], s41 offen offset:1024 nt lds
    buffer_load_dwordx4 v12, s[12:15], s41 offen offset:2048 nt lds
    buffer_load_dwordx4 v12, s[12:15], s41 offen offset:3072 nt lds
    s_xor_b32 s42, s92, 0
    s_lshl_b32 s42, s42, 17
    s_add_u32 s41, s47, s42
    s_add_u32 m0, s50, 0x20000
    s_nop 0
    buffer_load_dwordx4 v22, s[28:31], s41 offen offset:0 lds
    s_add_u32 s41, s41, 0xc00
    buffer_load_dwordx4 v22, s[28:31], s41 offen offset:1024 lds
    s_add_u32 s41, s41, 0xc00
    buffer_load_dwordx4 v22, s[28:31], s41 offen offset:2048 lds
    s_add_u32 s41, s41, 0xc00
    buffer_load_dwordx4 v22, s[28:31], s41 offen offset:3072 lds
    s_waitcnt vmcnt(12) lgkmcnt(0)
    s_barrier
    s_add_u32 s42, s6, 3
    s_and_b32 s42, s42, 7
    s_lshl_b32 s42, s42, 14
    s_add_u32 s41, s40, s42
    s_add_u32 m0, s50, 0x8000
    s_nop 0
    buffer_load_dwordx4 v8, s[8:11], s41 offen offset:0 nt lds
    buffer_load_dwordx4 v9, s[8:11], s41 offen offset:1024 nt lds
    buffer_load_dwordx4 v10, s[8:11], s41 offen offset:2048 nt lds
    buffer_load_dwordx4 v11, s[8:11], s41 offen offset:3072 nt lds
    s_add_u32 s42, s6, 2
    s_and_b32 s42, s42, 7
    s_lshl_b32 s42, s42, 14
    s_add_u32 s41, s40, s42
    s_add_u32 m0, s50, 0x10000
    s_nop 0
    buffer_load_dwordx4 v12, s[12:15], s41 offen offset:0 nt lds
    buffer_load_dwordx4 v12, s[12:15], s41 offen offset:1024 nt lds
    buffer_load_dwordx4 v12, s[12:15], s41 offen offset:2048 nt lds
    buffer_load_dwordx4 v12, s[12:15], s41 offen offset:3072 nt lds
    s_waitcnt vmcnt(12) lgkmcnt(0)
    s_barrier
    ds_read_b128 v[128:131], v14 offset:0
    ds_read_b128 v[132:135], v14 offset:1024
    ds_read_b128 v[136:139], v14 offset:2048
    ds_read_b128 v[140:143], v14 offset:3072
    ds_read_b128 v[144:147], v14 offset:4096
    ds_read_b128 v[148:151], v14 offset:5120
    ds_read_b128 v[152:155], v14 offset:6144
    ds_read_b128 v[156:159], v14 offset:7168
    v_mov_b32 v2, 0x24000
    ds_read_b32 v3, v2
    s_waitcnt lgkmcnt(0)
    v_readfirstlane_b32 s98, v3
    s_cmp_lt_u32 s36, 2
    s_mov_b32 s41, 0x0
    s_cselect_b32 s41, 0xffff4000, s41
    v_add_u32 v14, s41, v14
    s_add_u32 s42, s6, 4
    s_and_b32 s42, s42, 7
    s_lshl_b32 s42, s42, 14
    s_add_u32 s41, s40, s42
    s_add_u32 m0, s50, 0x0
    s_nop 0
    buffer_load_dwordx4 v8, s[8:11], s41 offen offset:0 nt lds
    buffer_load_dwordx4 v9, s[8:11], s41 offen offset:1024 nt lds
    buffer_load_dwordx4 v10, s[8:11], s41 offen offset:2048 nt lds
    buffer_load_dwordx4 v11, s[8:11], s41 offen offset:3072 nt lds
    s_add_u32 s42, s6, 3
    s_and_b32 s42, s42, 7
    s_lshl_b32 s42, s42, 14
    s_add_u32 s41, s40, s42
    s_add_u32 m0, s50, 0x14000
    s_nop 0
    buffer_load_dwordx4 v12, s[12:15], s41 offen offset:0 nt lds
    buffer_load_dwordx4 v12, s[12:15], s41 offen offset:1024 nt lds
    buffer_load_dwordx4 v12, s[12:15], s41 offen offset:2048 nt lds
    buffer_load_dwordx4 v12, s[12:15], s41 offen offset:3072 nt lds
    s_xor_b32 s42, s92, 0
    s_lshl_b32 s42, s42, 13
    s_add_u32 s41, s75, s42
    buffer_store_dwordx4 v[128:131], v7, s[24:27], s41 offen offset:0 sc1
    buffer_store_dwordx4 v[132:135], v7, s[24:27], s41 offen offset:1024 sc1
    buffer_store_dwordx4 v[136:139], v7, s[24:27], s41 offen offset:2048 sc1
    buffer_store_dwordx4 v[140:143], v7, s[24:27], s41 offen offset:3072 sc1
    s_add_u32 s41, s41, 4096
    buffer_store_dwordx4 v[144:147], v7, s[24:27], s41 offen offset:0 sc1
    buffer_store_dwordx4 v[148:151], v7, s[24:27], s41 offen offset:1024 sc1
    buffer_store_dwordx4 v[152:155], v7, s[24:27], s41 offen offset:2048 sc1
    buffer_store_dwordx4 v[156:159], v7, s[24:27], s41 offen offset:3072 sc1
    s_waitcnt vmcnt(16) lgkmcnt(0)
    s_barrier
    ds_read_b64_tr_b16 v[32:33], v28 offset:0
    ds_read_b64_tr_b16 v[34:35], v28 offset:1024
    ds_read_b64_tr_b16 v[36:37], v29 offset:0
    ds_read_b64_tr_b16 v[38:39], v29 offset:1024
    ds_read_b64_tr_b16 v[40:41], v30 offset:0
    ds_read_b64_tr_b16 v[42:43], v30 offset:1024
    ds_read_b64_tr_b16 v[44:45], v31 offset:0
    ds_read_b64_tr_b16 v[46:47], v31 offset:1024
    ds_read_b64_tr_b16 v[48:49], v28 offset:4096
    ds_read_b64_tr_b16 v[50:51], v28 offset:5120
    s_waitcnt lgkmcnt(8)
    v_mfma_f32_32x32x16_bf16 v[64:79], v[32:35], v[128:131], 0
    ds_read_b64_tr_b16 v[52:53], v29 offset:4096
    ds_read_b64_tr_b16 v[54:55], v29 offset:5120
    s_add_u32 s42, s6, 5
    s_and_b32 s42, s42, 7
    s_lshl_b32 s42, s42, 14
    s_add_u32 s41, s40, s42
    s_add_u32 m0, s50, 0x4000
    s_nop 0
    buffer_load_dwordx4 v8, s[8:11], s41 offen offset:0 nt lds
    s_waitcnt lgkmcnt(8)
    v_mfma_f32_32x32x16_bf16 v[80:95], v[36:39], v[128:131], 0
    ds_read_b64_tr_b16 v[56:57], v30 offset:4096
    ds_read_b64_tr_b16 v[58:59], v30 offset:5120
    buffer_load_dwordx4 v9, s[8:11], s41 offen offset:1024 nt lds
    s_waitcnt lgkmcnt(8)
    v_mfma_f32_32x32x16_bf16 v[96:111], v[40:43], v[128:131], 0
    ds_read_b64_tr_b16 v[60:61], v31 offset:4096
    ds_read_b64_tr_b16 v[62:63], v31 offset:5120
    buffer_load_dwordx4 v10, s[8:11], s41 offen offset:2048 nt lds
    s_waitcnt lgkmcnt(8)
    v_mfma_f32_32x32x16_bf16 v[112:127], v[44:47], v[128:131], 0
    ds_read_b64_tr_b16 v[32:33], v28 offset:8192
    ds_read_b64_tr_b16 v[34:35], v28 offset:9216
    buffer_load_dwordx4 v11, s[8:11], s41 offen offset:3072 nt lds
    s_waitcnt lgkmcnt(8)
    v_mfma_f32_32x32x16_bf16 v[64:79], v[48:51], v[132:135], v[64:79]
    ds_read_b64_tr_b16 v[36:37], v29 offset:8192
    ds_read_b64_tr_b16 v[38:39], v29 offset:9216
    s_add_u32 s42, s6, 4
    s_and_b32 s42, s42, 7
    s_lshl_b32 s42, s42, 14
    s_add_u32 s41, s40, s42
    s_add_u32 m0, s50, 0xc000
    s_nop 0
    buffer_load_dwordx4 v12, s[12:15], s41 offen offset:0 nt lds
    s_waitcnt lgkmcnt(8)
    v_mfma_f32_32x32x16_bf16 v[80:95], v[52:55], v[132:135], v[80:95]
    ds_read_b64_tr_b16 v[40:41], v30 offset:8192
    ds_read_b64_tr_b16 v[42:43], v30 offset:9216
    buffer_load_dwordx4 v12, s[12:15], s41 offen offset:1024 nt lds
    s_waitcnt lgkmcnt(8)
    v_mfma_f32_32x32x16_bf16 v[96:111], v[56:59], v[132:135], v[96:111]
    ds_read_b64_tr_b16 v[44:45], v31 offset:8192
    ds_read_b64_tr_b16 v[46:47], v31 offset:9216
    buffer_load_dwordx4 v12, s[12:15], s41 offen offset:2048 nt lds
    s_waitcnt lgkmcnt(8)
    v_mfma_f32_32x32x16_bf16 v[112:127], v[60:63], v[132:135], v[112:127]
    ds_read_b64_tr_b16 v[48:49], v28 offset:12288
    ds_read_b64_tr_b16 v[50:51], v28 offset:13312
    buffer_load_dwordx4 v12, s[12:15], s41 offen offset:3072 nt lds
    s_waitcnt lgkmcnt(8)
    v_mfma_f32_32x32x16_bf16 v[64:79], v[32:35], v[136:139], v[64:79]
    ds_read_b64_tr_b16 v[52:53], v29 offset:12288
    ds_read_b64_tr_b16 v[54:55], v29 offset:13312
    s_waitcnt lgkmcnt(8)
    v_mfma_f32_32x32x16_bf16 v[80:95], v[36:39], v[136:139], v[80:95]
    ds_read_b64_tr_b16 v[56:57], v30 offset:12288
    ds_read_b64_tr_b16 v[58:59], v30 offset:13312
    s_xor_b32 s42, s92, 0
    s_lshl_b32 s42, s42, 17
    s_add_u32 s41, s47, s42
    s_add_u32 s41, s41, 0x10000
    s_add_u32 m0, s50, 0x24000
    s_nop 0
    buffer_load_dwordx4 v22, s[28:31], s41 offen offset:0 lds
    s_waitcnt lgkmcnt(8)
    v_mfma_f32_32x32x16_bf16 v[96:111], v[40:43], v[136:139], v[96:111]
    ds_read_b64_tr_b16 v[60:61], v31 offset:12288
    ds_read_b64_tr_b16 v[62:63], v31 offset:13312
    s_waitcnt lgkmcnt(8)
    v_mfma_f32_32x32x16_bf16 v[112:127], v[44:47], v[136:139], v[112:127]
    s_add_u32 s41, s41, 0xc00
    buffer_load_dwordx4 v22, s[28:31], s41 offen offset:1024 lds
    s_waitcnt lgkmcnt(6)
    v_mfma_f32_32x32x16_bf16 v[64:79], v[48:51], v[140:143], v[64:79]
    s_waitcnt lgkmcnt(4)
    v_mfma_f32_32x32x16_bf16 v[80:95], v[52:55], v[140:143], v[80:95]
    s_add_u32 s41, s41, 0xc00
    buffer_load_dwordx4 v22, s[28:31], s41 offen offset:2048 lds
    s_waitcnt lgkmcnt(2)
    v_mfma_f32_32x32x16_bf16 v[96:111], v[56:59], v[140:143], v[96:111]
    s_waitcnt lgkmcnt(0)
    v_mfma_f32_32x32x16_bf16 v[112:127], v[60:63], v[140:143], v[112:127]
    s_add_u32 s41, s41, 0xc00
    buffer_load_dwordx4 v22, s[28:31], s41 offen offset:3072 lds
    s_waitcnt vmcnt(12) lgkmcnt(0)
    s_barrier
    s_add_u32 s42, s6, 6
    s_and_b32 s42, s42, 7
    s_lshl_b32 s42, s42, 14
    s_add_u32 s41, s40, s42
    s_add_u32 m0, s50, 0x8000
    s_nop 0
    buffer_load_dwordx4 v8, s[8:11], s41 offen offset:0 nt lds
    buffer_load_dwordx4 v9, s[8:11], s41 offen offset:1024 nt lds
    buffer_load_dwordx4 v10, s[8:11], s41 offen offset:2048 nt lds
    buffer_load_dwordx4 v11, s[8:11], s41 offen offset:3072 nt lds
    s_add_u32 s42, s6, 5
    s_and_b32 s42, s42, 7
    s_lshl_b32 s42, s42, 14
    s_add_u32 s41, s40, s42
    s_add_u32 m0, s50, 0x10000
    s_nop 0
    buffer_load_dwordx4 v12, s[12:15], s41 offen offset:0 nt lds
    buffer_load_dwordx4 v12, s[12:15], s41 offen offset:1024 nt lds
    buffer_load_dwordx4 v12, s[12:15], s41 offen offset:2048 nt lds
    buffer_load_dwordx4 v12, s[12:15], s41 offen offset:3072 nt lds
    s_xor_b32 s42, s93, 0
    s_lshl_b32 s42, s42, 17
    s_add_u32 s41, s47, s42
    s_add_u32 m0, s50, 0x18000
    s_nop 0
    buffer_load_dwordx4 v22, s[28:31], s41 offen offset:0 lds
    s_add_u32 s41, s41, 0xc00
    buffer_load_dwordx4 v22, s[28:31], s41 offen offset:1024 lds
    s_add_u32 s41, s41, 0xc00
    buffer_load_dwordx4 v22, s[28:31], s41 offen offset:2048 lds
    s_add_u32 s41, s41, 0xc00
    buffer_load_dwordx4 v22, s[28:31], s41 offen offset:3072 lds
    s_waitcnt vmcnt(12) lgkmcnt(0)
    s_barrier
    s_cmp_lg_u32 s74, 4
    s_cbranch_scc1 L_pi0
    buffer_load_dwordx4 v[24:27], v6, s[24:27], s86 offen sc1
L_pi0:
    ds_read_b64_tr_b16 v[32:33], v28 offset:16384
    ds_read_b64_tr_b16 v[34:35], v28 offset:17408
    ds_read_b64_tr_b16 v[36:37], v29 offset:16384
    ds_read_b64_tr_b16 v[38:39], v29 offset:17408
    ds_read_b64_tr_b16 v[40:41], v30 offset:16384
    ds_read_b64_tr_b16 v[42:43], v30 offset:17408
    ds_read_b64_tr_b16 v[44:45], v31 offset:16384
    ds_read_b64_tr_b16 v[46:47], v31 offset:17408
    ds_read_b64_tr_b16 v[48:49], v28 offset:20480
    ds_read_b64_tr_b16 v[50:51], v28 offset:21504
    s_waitcnt lgkmcnt(8)
    v_mfma_f32_32x32x16_bf16 v[64:79], v[32:35], v[144:147], v[64:79]
    ds_read_b64_tr_b16 v[52:53], v29 offset:20480
    ds_read_b64_tr_b16 v[54:55], v29 offset:21504
    s_add_u32 s42, s6, 7
    s_and_b32 s42, s42, 7
    s_lshl_b32 s42, s42, 14
    s_add_u32 s41, s40, s42
    s_add_u32 m0, s50, 0x0
    s_nop 0
    buffer_load_dwordx4 v8, s[8:11], s41 offen offset:0 nt lds
    s_waitcnt lgkmcnt(8)
    v_mfma_f32_32x32x16_bf16 v[80:95], v[36:39], v[144:147], v[80:95]
    ds_read_b64_tr_b16 v[56:57], v30 offset:20480
    ds_read_b64_tr_b16 v[58:59], v30 offset:21504
    buffer_load_dwordx4 v9, s[8:11], s41 offen offset:1024 nt lds
    s_waitcnt lgkmcnt(8)
    v_mfma_f32_32x32x16_bf16 v[96:111], v[40:43], v[144:147], v[96:111]
    ds_read_b64_tr_b16 v[60:61], v31 offset:20480
    ds_read_b64_tr_b16 v[62:63], v31 offset:21504
    buffer_load_dwordx4 v10, s[8:11], s41 offen offset:2048 nt lds
    s_waitcnt lgkmcnt(8)
    v_mfma_f32_32x32x16_bf16 v[112:127], v[44:47], v[144:147], v[112:127]
    ds_read_b64_tr_b16 v[32:33], v28 offset:24576
    ds_read_b64_tr_b16 v[34:35], v28 offset:25600
    buffer_load_dwordx4 v11, s[8:11], s41 offen offset:3072 nt lds
    s_waitcnt lgkmcnt(8)
    v_mfma_f32_32x32x16_bf16 v[64:79], v[48:51], v[148:151], v[64:79]
    ds_read_b64_tr_b16 v[36:37], v29 offset:24576
    ds_read_b64_tr_b16 v[38:39], v29 offset:25600
    s_add_u32 s42, s6, 6
    s_and_b32 s42, s42, 7
    s_lshl_b32 s42, s42, 14
    s_add_u32 s41, s40, s42
    s_add_u32 m0, s50, 0x14000
    s_nop 0
    buffer_load_dwordx4 v12, s[12:15], s41 offen offset:0 nt lds
    s_waitcnt lgkmcnt(8)
    v_mfma_f32_32x32x16_bf16 v[80:95], v[52:55], v[148:151], v[80:95]
    ds_read_b64_tr_b16 v[40:41], v30 offset:24576
    ds_read_b64_tr_b16 v[42:43], v30 offset:25600
    buffer_load_dwordx4 v12, s[12:15], s41 offen offset:1024 nt lds
    s_waitcnt lgkmcnt(8)
    v_mfma_f32_32x32x16_bf16 v[96:111], v[56:59], v[148:151], v[96:111]
    ds_read_b64_tr_b16 v[44:45], v31 offset:24576
    ds_read_b64_tr_b16 v[46:47], v31 offset:25600
    buffer_load_dwordx4 v12, s[12:15], s41 offen offset:2048 nt lds
    s_waitcnt lgkmcnt(8)
    v_mfma_f32_32x32x16_bf16 v[112:127], v[60:63], v[148:151], v[112:127]
    ds_read_b64_tr_b16 v[48:49], v28 offset:28672
    ds_read_b64_tr_b16 v[50:51], v28 offset:29696
    buffer_load_dwordx4 v12, s[12:15], s41 offen offset:3072 nt lds
    s_waitcnt lgkmcnt(8)
    v_mfma_f32_32x32x16_bf16 v[64:79], v[32:35], v[152:155], v[64:79]
    ds_read_b64_tr_b16 v[52:53], v29 offset:28672
    ds_read_b64_tr_b16 v[54:55], v29 offset:29696
    s_waitcnt lgkmcnt(8)
    v_mfma_f32_32x32x16_bf16 v[80:95], v[36:39], v[152:155], v[80:95]
    ds_read_b64_tr_b16 v[56:57], v30 offset:28672
    ds_read_b64_tr_b16 v[58:59], v30 offset:29696
    s_xor_b32 s42, s93, 0
    s_lshl_b32 s42, s42, 17
    s_add_u32 s41, s47, s42
    s_add_u32 s41, s41, 0x10000
    s_add_u32 m0, s50, 0x1c000
    s_nop 0
    buffer_load_dwordx4 v22, s[28:31], s41 offen offset:0 lds
    s_waitcnt lgkmcnt(8)
    v_mfma_f32_32x32x16_bf16 v[96:111], v[40:43], v[152:155], v[96:111]
    ds_read_b64_tr_b16 v[60:61], v31 offset:28672
    ds_read_b64_tr_b16 v[62:63], v31 offset:29696
    s_waitcnt lgkmcnt(8)
    v_mfma_f32_32x32x16_bf16 v[112:127], v[44:47], v[152:155], v[112:127]
    s_add_u32 s41, s41, 0xc00
    buffer_load_dwordx4 v22, s[28:31], s41 offen offset:1024 lds
    s_waitcnt lgkmcnt(6)
    v_mfma_f32_32x32x16_bf16 v[64:79], v[48:51], v[156:159], v[64:79]
    s_waitcnt lgkmcnt(4)
    v_mfma_f32_32x32x16_bf16 v[80:95], v[52:55], v[156:159], v[80:95]
    s_add_u32 s41, s41, 0xc00
    buffer_load_dwordx4 v22, s[28:31], s41 offen offset:2048 lds
    s_waitcnt lgkmcnt(2)
    v_mfma_f32_32x32x16_bf16 v[96:111], v[56:59], v[156:159], v[96:111]
    s_waitcnt lgkmcnt(0)
    v_mfma_f32_32x32x16_bf16 v[112:127], v[60:63], v[156:159], v[112:127]
    s_add_u32 s41, s41, 0xc00
    buffer_load_dwordx4 v22, s[28:31], s41 offen offset:3072 lds
    s_waitcnt vmcnt(12) lgkmcnt(0)
    s_cmp_lg_u32 s74, 4
    s_cbranch_scc1 L_ok0
    s_mov_b32 s43, 0
L_pc0:
    v_xor_b32 v24, s98, v24
    v_xor_b32 v25, s98, v25
    v_xor_b32 v26, s98, v26
    v_xor_b32 v27, s98, v27
    v_or3_b32 v24, v24, v25, v26
    v_or_b32 v24, v24, v27
    s_nop 0
    v_readfirstlane_b32 s41, v24
    s_nop 1
    s_cmp_eq_u32 s41, 0
    s_cbranch_scc1 L_ok0
    s_add_u32 s43, s43, 1
    s_cmp_gt_u32 s43, 0x40000
    s_cbranch_scc1 L_ok0
    buffer_load_dwordx4 v[24:27], v6, s[24:27], s86 offen sc1
    s_waitcnt vmcnt(0)
    s_branch L_pc0
L_ok0:
    s_barrier
    s_xor_b32 s42, s93, 0
    s_lshl_b32 s42, s42, 13
    s_add_u32 s41, s75, s42
    buffer_load_dwordx4 v[160:163], v7, s[24:27], s41 offen offset:0 sc1
    buffer_load_dwordx4 v[164:167], v7, s[24:27], s41 offen offset:1024 sc1
    buffer_load_dwordx4 v[168:171], v7, s[24:27], s41 offen offset:2048 sc1
    buffer_load_dwordx4 v[172:175], v7, s[24:27], s41 offen offset:3072 sc1
    s_add_u32 s41, s41, 4096
    buffer_load_dwordx4 v[176:179], v7, s[24:27], s41 offen offset:0 sc1
    buffer_load_dwordx4 v[180:183], v7, s[24:27], s41 offen offset:1024 sc1
    buffer_load_dwordx4 v[184:187], v7, s[24:27], s41 offen offset:2048 sc1
    buffer_load_dwordx4 v[188:191], v7, s[24:27], s41 offen offset:3072 sc1
    s_add_u32 s42, s6, 7
    s_and_b32 s42, s42, 7
    s_lshl_b32 s42, s42, 14
    s_add_u32 s41, s40, s42
    s_add_u32 m0, s50, 0xc000
    s_nop 0
    buffer_load_dwordx4 v12, s[12:15], s41 offen offset:0 nt lds
    buffer_load_dwordx4 v12, s[12:15], s41 offen offset:1024 nt lds
    buffer_load_dwordx4 v12, s[12:15], s41 offen offset:2048 nt lds
    buffer_load_dwordx4 v12, s[12:15], s41 offen offset:3072 nt lds
    s_xor_b32 s42, s95, 0
    s_lshl_b32 s42, s42, 17
    s_add_u32 s41, s47, s42
    s_add_u32 m0, s50, 0x4000
    s_nop 0
    buffer_load_dwordx4 v22, s[28:31], s41 offen offset:0 lds
    s_add_u32 s41, s41, 0xc00
    buffer_load_dwordx4 v22, s[28:31], s41 offen offset:1024 lds
    s_add_u32 s41, s41, 0xc00
    buffer_load_dwordx4 v22, s[28:31], s41 offen offset:2048 lds
    s_add_u32 s41, s41, 0xc00
    buffer_load_dwordx4 v22, s[28:31], s41 offen offset:3072 lds
    s_xor_b32 s42, s94, 0
    s_lshl_b32 s42, s42, 17
    s_add_u32 s41, s47, s42
    s_add_u32 m0, s50, 0x20000
    s_nop 0
    buffer_load_dwordx4 v22, s[28:31], s41 offen offset:0 lds
    s_add_u32 s41, s41, 0xc00
    buffer_load_dwordx4 v22, s[28:31], s41 offen offset:1024 lds
    s_add_u32 s41, s41, 0xc00
    buffer_load_dwordx4 v22, s[28:31], s41 offen offset:2048 lds
    s_add_u32 s41, s41, 0xc00
    buffer_load_dwordx4 v22, s[28:31], s41 offen offset:3072 lds
    s_waitcnt vmcnt(24) lgkmcnt(0)
    s_barrier
    v_add_u32 v28, 0xffff8000, v28
    v_add_u32 v29, 0xffff8000, v29
    v_add_u32 v30, 0xffff8000, v30
    v_add_u32 v31, 0xffff8000, v31
    ds_read_b64_tr_b16 v[32:33], v28 offset:0
    ds_read_b64_tr_b16 v[34:35], v28 offset:1024
    ds_read_b64_tr_b16 v[36:37], v29 offset:0
    ds_read_b64_tr_b16 v[38:39], v29 offset:1024
    ds_read_b64_tr_b16 v[40:41], v30 offset:0
    ds_read_b64_tr_b16 v[42:43], v30 offset:1024
    ds_read_b64_tr_b16 v[44:45], v31 offset:0
    ds_read_b64_tr_b16 v[46:47], v31 offset:1024
    ds_read_b64_tr_b16 v[48:49], v28 offset:4096
    ds_read_b64_tr_b16 v[50:51], v28 offset:5120
    s_waitcnt vmcnt(19) lgkmcnt(8)
    v_mfma_f32_32x32x16_bf16 v[64:79], v[32:35], v[160:163], v[64:79]
    ds_read_b64_tr_b16 v[52:53], v29 offset:4096
    ds_read_b64_tr_b16 v[54:55], v29 offset:5120
    s_xor_b32 s42, s94, 0
    s_lshl_b32 s42, s42, 13
    s_add_u32 s41, s75, s42
    buffer_load_dwordx4 v[192:195], v7, s[24:27], s41 offen offset:0 sc1
    s_waitcnt lgkmcnt(8)
    v_mfma_f32_32x32x16_bf16 v[80:95], v[36:39], v[160:163], v[80:95]
    ds_read_b64_tr_b16 v[56:57], v30 offset:4096
    ds_read_b64_tr_b16 v[58:59], v30 offset:5120
    buffer_load_dwordx4 v[196:199], v7, s[24:27], s41 offen offset:1024 sc1
    buffer_load_dwordx4 v[200:203], v7, s[24:27], s41 offen offset:2048 sc1
    s_waitcnt lgkmcnt(8)
    v_mfma_f32_32x32x16_bf16 v[96:111], v[40:43], v[160:163], v[96:111]
    ds_read_b64_tr_b16 v[60:61], v31 offset:4096
    ds_read_b64_tr_b16 v[62:63], v31 offset:5120
    buffer_load_dwordx4 v[204:207], v7, s[24:27], s41 offen offset:3072 sc1
    s_waitcnt lgkmcnt(8)
    v_mfma_f32_32x32x16_bf16 v[112:127], v[44:47], v[160:163], v[112:127]
    ds_read_b64_tr_b16 v[32:33], v28 offset:8192
    ds_read_b64_tr_b16 v[34:35], v28 offset:9216
    s_add_u32 s41, s41, 4096
    buffer_load_dwordx4 v[208:211], v7, s[24:27], s41 offen offset:0 sc1
    buffer_load_dwordx4 v[212:215], v7, s[24:27], s41 offen offset:1024 sc1
    s_waitcnt vmcnt(24) lgkmcnt(8)
    v_mfma_f32_32x32x16_bf16 v[64:79], v[48:51], v[164:167], v[64:79]
    ds_read_b64_tr_b16 v[36:37], v29 offset:8192
    ds_read_b64_tr_b16 v[38:39], v29 offset:9216
    buffer_load_dwordx4 v[216:219], v7, s[24:27], s41 offen offset:2048 sc1
    s_waitcnt lgkmcnt(8)
    v_mfma_f32_32x32x16_bf16 v[80:95], v[52:55], v[164:167], v[80:95]
    ds_read_b64_tr_b16 v[40:41], v30 offset:8192
    ds_read_b64_tr_b16 v[42:43], v30 offset:9216
    buffer_load_dwordx4 v[220:223], v7, s[24:27], s41 offen offset:3072 sc1
    s_xor_b32 s42, s95, 0
    s_lshl_b32 s42, s42, 17
    s_add_u32 s41, s47, s42
    s_add_u32 s41, s41, 0x10000
    s_add_u32 m0, s50, 0x8000
    s_nop 0
    buffer_load_dwordx4 v22, s[28:31], s41 offen offset:0 lds
    s_waitcnt lgkmcnt(8)
    v_mfma_f32_32x32x16_bf16 v[96:111], v[56:59], v[164:167], v[96:111]
    ds_read_b64_tr_b16 v[44:45], v31 offset:8192
    ds_read_b64_tr_b16 v[46:47], v31 offset:9216
    s_add_u32 s41, s41, 0xc00
    buffer_load_dwordx4 v22, s[28:31], s41 offen offset:1024 lds
    s_waitcnt lgkmcnt(8)
    v_mfma_f32_32x32x16_bf16 v[112:127], v[60:63], v[164:167], v[112:127]
    ds_read_b64_tr_b16 v[48:49], v28 offset:12288
    ds_read_b64_tr_b16 v[50:51], v28 offset:13312
    s_add_u32 s41, s41, 0xc00
    buffer_load_dwordx4 v22, s[28:31], s41 offen offset:2048 lds
    s_add_u32 s41, s41, 0xc00
    buffer_load_dwordx4 v22, s[28:31], s41 offen offset:3072 lds
    s_waitcnt vmcnt(29) lgkmcnt(8)
    v_mfma_f32_32x32x16_bf16 v[64:79], v[32:35], v[168:171], v[64:79]
    ds_read_b64_tr_b16 v[52:53], v29 offset:12288
    ds_read_b64_tr_b16 v[54:55], v29 offset:13312
    s_xor_b32 s42, s95, 0
    s_lshl_b32 s42, s42, 13
    s_add_u32 s41, s75, s42
    buffer_load_dwordx4 v[224:227], v7, s[24:27], s41 offen offset:0 sc1
    buffer_load_dwordx4 v[228:231], v7, s[24:27], s41 offen offset:1024 sc1
    s_waitcnt lgkmcnt(8)
    v_mfma_f32_32x32x16_bf16 v[80:95], v[36:39], v[168:171], v[80:95]
    ds_read_b64_tr_b16 v[56:57], v30 offset:12288
    ds_read_b64_tr_b16 v[58:59], v30 offset:13312
    buffer_load_dwordx4 v[232:235], v7, s[24:27], s41 offen offset:2048 sc1
    buffer_load_dwordx4 v[236:239], v7, s[24:27], s41 offen offset:3072 sc1
    s_waitcnt lgkmcnt(8)
    v_mfma_f32_32x32x16_bf16 v[96:111], v[40:43], v[168:171], v[96:111]
    ds_read_b64_tr_b16 v[60:61], v31 offset:12288
    ds_read_b64_tr_b16 v[62:63], v31 offset:13312
    s_add_u32 s41, s41, 4096
    buffer_load_dwordx4 v[240:243], v7, s[24:27], s41 offen offset:0 sc1
    buffer_load_dwordx4 v[244:247], v7, s[24:27], s41 offen offset:1024 sc1
    s_waitcnt lgkmcnt(8)
    v_mfma_f32_32x32x16_bf16 v[112:127], v[44:47], v[168:171], v[112:127]
    buffer_load_dwordx4 v[248:251], v7, s[24:27], s41 offen offset:2048 sc1
    buffer_load_dwordx4 v[252:255], v7, s[24:27], s41 offen offset:3072 sc1
    s_waitcnt vmcnt(36) lgkmcnt(6)
    v_mfma_f32_32x32x16_bf16 v[64:79], v[48:51], v[172:175], v[64:79]
    s_xor_b32 s42, s94, 0
    s_lshl_b32 s42, s42, 17
    s_add_u32 s41, s47, s42
    s_add_u32 s41, s41, 0x10000
    s_add_u32 m0, s50, 0x24000
    s_nop 0
    buffer_load_dwordx4 v22, s[28:31], s41 offen offset:0 lds
    s_add_u32 s41, s41, 0xc00
    buffer_load_dwordx4 v22, s[28:31], s41 offen offset:1024 lds
    s_waitcnt lgkmcnt(4)
    v_mfma_f32_32x32x16_bf16 v[80:95], v[52:55], v[172:175], v[80:95]
    s_add_u32 s41, s41, 0xc00
    buffer_load_dwordx4 v22, s[28:31], s41 offen offset:2048 lds
    s_add_u32 s41, s41, 0xc00
    buffer_load_dwordx4 v22, s[28:31], s41 offen offset:3072 lds
    s_waitcnt lgkmcnt(2)
    v_mfma_f32_32x32x16_bf16 v[96:111], v[56:59], v[172:175], v[96:111]
    s_xor_b32 s42, s92, 1
    s_lshl_b32 s42, s42, 17
    s_add_u32 s41, s47, s42
    s_add_u32 m0, s50, 0x10000
    s_nop 0
    buffer_load_dwordx4 v22, s[28:31], s41 offen offset:0 lds
    s_add_u32 s41, s41, 0xc00
    buffer_load_dwordx4 v22, s[28:31], s41 offen offset:1024 lds
    s_waitcnt lgkmcnt(0)
    v_mfma_f32_32x32x16_bf16 v[112:127], v[60:63], v[172:175], v[112:127]
    s_add_u32 s41, s41, 0xc00
    buffer_load_dwordx4 v22, s[28:31], s41 offen offset:2048 lds
    s_add_u32 s41, s41, 0xc00
    buffer_load_dwordx4 v22, s[28:31], s41 offen offset:3072 lds
    s_waitcnt vmcnt(36) lgkmcnt(0)
    s_barrier
    ds_read_b64_tr_b16 v[32:33], v28 offset:16384
    ds_read_b64_tr_b16 v[34:35], v28 offset:17408
    ds_read_b64_tr_b16 v[36:37], v29 offset:16384
    ds_read_b64_tr_b16 v[38:39], v29 offset:17408
    ds_read_b64_tr_b16 v[40:41], v30 offset:16384
    ds_read_b64_tr_b16 v[42:43], v30 offset:17408
    ds_read_b64_tr_b16 v[44:45], v31 offset:16384
    ds_read_b64_tr_b16 v[46:47], v31 offset:17408
    ds_read_b64_tr_b16 v[48:49], v28 offset:20480
    ds_read_b64_tr_b16 v[50:51], v28 offset:21504
    s_waitcnt lgkmcnt(8)
    v_mfma_f32_32x32x16_bf16 v[64:79], v[32:35], v[176:179], v[64:79]
    ds_read_b64_tr_b16 v[52:53], v29 offset:20480
    ds_read_b64_tr_b16 v[54:55], v29 offset:21504
    s_waitcnt lgkmcnt(8)
    v_mfma_f32_32x32x16_bf16 v[80:95], v[36:39], v[176:179], v[80:95]
    ds_read_b64_tr_b16 v[56:57], v30 offset:20480
    ds_read_b64_tr_b16 v[58:59], v30 offset:21504
    s_xor_b32 s42, s93, 1
    s_lshl_b32 s42, s42, 17
    s_add_u32 s41, s47, s42
    s_add_u32 m0, s50, 0x0
    s_nop 0
    buffer_load_dwordx4 v22, s[28:31], s41 offen offset:0 lds
    s_waitcnt lgkmcnt(8)
    v_mfma_f32_32x32x16_bf16 v[96:111], v[40:43], v[176:179], v[96:111]
    ds_read_b64_tr_b16 v[60:61], v31 offset:20480
    ds_read_b64_tr_b16 v[62:63], v31 offset:21504
    s_waitcnt lgkmcnt(8)
    v_mfma_f32_32x32x16_bf16 v[112:127], v[44:47], v[176:179], v[112:127]
    ds_read_b64_tr_b16 v[32:33], v28 offset:24576
    ds_read_b64_tr_b16 v[34:35], v28 offset:25600
    s_add_u32 s41, s41, 0xc00
    buffer_load_dwordx4 v22, s[28:31], s41 offen offset:1024 lds
    s_waitcnt lgkmcnt(8)
    v_mfma_f32_32x32x16_bf16 v[64:79], v[48:51], v[180:183], v[64:79]
    ds_read_b64_tr_b16 v[36:37], v29 offset:24576
    ds_read_b64_tr_b16 v[38:39], v29 offset:25600
    s_waitcnt lgkmcnt(8)
    v_mfma_f32_32x32x16_bf16 v[80:95], v[52:55], v[180:183], v[80:95]
    ds_read_b64_tr_b16 v[40:41], v30 offset:24576
    ds_read_b64_tr_b16 v[42:43], v30 offset:25600
    s_add_u32 s41, s41, 0xc00
    buffer_load_dwordx4 v22, s[28:31], s41 offen offset:2048 lds
    s_waitcnt lgkmcnt(8)
    v_mfma_f32_32x32x16_bf16 v[96:111], v[56:59], v[180:183], v[96:111]
    ds_read_b64_tr_b16 v[44:45], v31 offset:24576
    ds_read_b64_tr_b16 v[46:47], v31 offset:25600
    s_waitcnt lgkmcnt(8)
    v_mfma_f32_32x32x16_bf16 v[112:127], v[60:63], v[180:183], v[112:127]
    ds_read_b64_tr_b16 v[48:49], v28 offset:28672
    ds_read_b64_tr_b16 v[50:51], v28 offset:29696
    s_add_u32 s41, s41, 0xc00
    buffer_load_dwordx4 v22, s[28:31], s41 offen offset:3072 lds
    s_waitcnt lgkmcnt(8)
    v_mfma_f32_32x32x16_bf16 v[64:79], v[32:35], v[184:187], v[64:79]
    ds_read_b64_tr_b16 v[52:53], v29 offset:28672
    ds_read_b64_tr_b16 v[54:55], v29 offset:29696
    s_xor_b32 s42, s92, 1
    s_lshl_b32 s42, s42, 17
    s_add_u32 s41, s47, s42
    s_add_u32 s41, s41, 0x10000
    s_add_u32 m0, s50, 0x18000
    s_nop 0
    buffer_load_dwordx4 v22, s[28:31], s41 offen offset:0 lds
    s_waitcnt lgkmcnt(8)
    v_mfma_f32_32x32x16_bf16 v[80:95], v[36:39], v[184:187], v[80:95]
    ds_read_b64_tr_b16 v[56:57], v30 offset:28672
    ds_read_b64_tr_b16 v[58:59], v30 offset:29696
    s_add_u32 s41, s41, 0xc00
    buffer_load_dwordx4 v22, s[28:31], s41 offen offset:1024 lds
    s_waitcnt lgkmcnt(8)
    v_mfma_f32_32x32x16_bf16 v[96:111], v[40:43], v[184:187], v[96:111]
    ds_read_b64_tr_b16 v[60:61], v31 offset:28672
    ds_read_b64_tr_b16 v[62:63], v31 offset:29696
    s_add_u32 s41, s41, 0xc00
    buffer_load_dwordx4 v22, s[28:31], s41 offen offset:2048 lds
    s_waitcnt lgkmcnt(8)
    v_mfma_f32_32x32x16_bf16 v[112:127], v[44:47], v[184:187], v[112:127]
    s_add_u32 s41, s41, 0xc00
    buffer_load_dwordx4 v22, s[28:31], s41 offen offset:3072 lds
    s_waitcnt lgkmcnt(6)
    v_mfma_f32_32x32x16_bf16 v[64:79], v[48:51], v[188:191], v[64:79]
    s_xor_b32 s42, s93, 1
    s_lshl_b32 s42, s42, 17
    s_add_u32 s41, s47, s42
    s_add_u32 s41, s41, 0x10000
    s_add_u32 m0, s50, 0x14000
    s_nop 0
    buffer_load_dwordx4 v22, s[28:31], s41 offen offset:0 lds
    s_waitcnt lgkmcnt(4)
    v_mfma_f32_32x32x16_bf16 v[80:95], v[52:55], v[188:191], v[80:95]
    s_add_u32 s41, s41, 0xc00
    buffer_load_dwordx4 v22, s[28:31], s41 offen offset:1024 lds
    s_waitcnt lgkmcnt(2)
    v_mfma_f32_32x32x16_bf16 v[96:111], v[56:59], v[188:191], v[96:111]
    s_add_u32 s41, s41, 0xc00
    buffer_load_dwordx4 v22, s[28:31], s41 offen offset:2048 lds
    s_waitcnt lgkmcnt(0)
    v_mfma_f32_32x32x16_bf16 v[112:127], v[60:63], v[188:191], v[112:127]
    s_add_u32 s41, s41, 0xc00
    buffer_load_dwordx4 v22, s[28:31], s41 offen offset:3072 lds
    s_waitcnt vmcnt(16) lgkmcnt(0)
    s_barrier
    ds_read_b64_tr_b16 v[32:33], v28 offset:32768
    ds_read_b64_tr_b16 v[34:35], v28 offset:33792
    ds_read_b64_tr_b16 v[36:37], v29 offset:32768
    ds_read_b64_tr_b16 v[38:39], v29 offset:33792
    ds_read_b64_tr_b16 v[40:41], v30 offset:32768
    ds_read_b64_tr_b16 v[42:43], v30 offset:33792
    ds_read_b64_tr_b16 v[44:45], v31 offset:32768
    ds_read_b64_tr_b16 v[46:47], v31 offset:33792
    ds_read_b64_tr_b16 v[48:49], v28 offset:36864
    ds_read_b64_tr_b16 v[50:51], v28 offset:37888
    s_waitcnt lgkmcnt(8)
    v_mfma_f32_32x32x16_bf16 v[64:79], v[32:35], v[192:195], v[64:79]
    ds_read_b64_tr_b16 v[52:53], v29 offset:36864
    ds_read_b64_tr_b16 v[54:55], v29 offset:37888
    s_waitcnt lgkmcnt(8)
    v_mfma_f32_32x32x16_bf16 v[80:95], v[36:39], v[192:195], v[80:95]
    ds_read_b64_tr_b16 v[56:57], v30 offset:36864
    ds_read_b64_tr_b16 v[58:59], v30 offset:37888
    s_waitcnt lgkmcnt(8)
    v_mfma_f32_32x32x16_bf16 v[96:111], v[40:43], v[192:195], v[96:111]
    ds_read_b64_tr_b16 v[60:61], v31 offset:36864
    ds_read_b64_tr_b16 v[62:63], v31 offset:37888
    s_waitcnt lgkmcnt(8)
    v_mfma_f32_32x32x16_bf16 v[112:127], v[44:47], v[192:195], v[112:127]
    ds_read_b64_tr_b16 v[32:33], v28 offset:40960
    ds_read_b64_tr_b16 v[34:35], v28 offset:41984
    s_waitcnt lgkmcnt(8)
    v_mfma_f32_32x32x16_bf16 v[64:79], v[48:51], v[196:199], v[64:79]
    ds_read_b64_tr_b16 v[36:37], v29 offset:40960
    ds_read_b64_tr_b16 v[38:39], v29 offset:41984
    s_waitcnt lgkmcnt(8)
    v_mfma_f32_32x32x16_bf16 v[80:95], v[52:55], v[196:199], v[80:95]
    ds_read_b64_tr_b16 v[40:41], v30 offset:40960
    ds_read_b64_tr_b16 v[42:43], v30 offset:41984
    s_waitcnt lgkmcnt(8)
    v_mfma_f32_32x32x16_bf16 v[96:111], v[56:59], v[196:199], v[96:111]
    ds_read_b64_tr_b16 v[44:45], v31 offset:40960
    ds_read_b64_tr_b16 v[46:47], v31 offset:41984
    s_waitcnt lgkmcnt(8)
    v_mfma_f32_32x32x16_bf16 v[112:127], v[60:63], v[196:199], v[112:127]
    ds_read_b64_tr_b16 v[48:49], v28 offset:45056
    ds_read_b64_tr_b16 v[50:51], v28 offset:46080
    s_waitcnt lgkmcnt(8)
    v_mfma_f32_32x32x16_bf16 v[64:79], v[32:35], v[200:203], v[64:79]
    ds_read_b64_tr_b16 v[52:53], v29 offset:45056
    ds_read_b64_tr_b16 v[54:55], v29 offset:46080
    s_waitcnt lgkmcnt(8)
    v_mfma_f32_32x32x16_bf16 v[80:95], v[36:39], v[200:203], v[80:95]
    ds_read_b64_tr_b16 v[56:57], v30 offset:45056
    ds_read_b64_tr_b16 v[58:59], v30 offset:46080
    s_waitcnt lgkmcnt(8)
    v_mfma_f32_32x32x16_bf16 v[96:111], v[40:43], v[200:203], v[96:111]
    ds_read_b64_tr_b16 v[60:61], v31 offset:45056
    ds_read_b64_tr_b16 v[62:63], v31 offset:46080
    s_waitcnt lgkmcnt(8)
    v_mfma_f32_32x32x16_bf16 v[112:127], v[44:47], v[200:203], v[112:127]
    ds_read_b64_tr_b16 v[32:33], v28 offset:49152
    ds_read_b64_tr_b16 v[34:35], v28 offset:50176
    s_waitcnt lgkmcnt(8)
    v_mfma_f32_32x32x16_bf16 v[64:79], v[48:51], v[204:207], v[64:79]
    ds_read_b64_tr_b16 v[36:37], v29 offset:49152
    ds_read_b64_tr_b16 v[38:39], v29 offset:50176
    s_waitcnt lgkmcnt(8)
    v_mfma_f32_32x32x16_bf16 v[80:95], v[52:55], v[204:207], v[80:95]
    ds_read_b64_tr_b16 v[40:41], v30 offset:49152
    ds_read_b64_tr_b16 v[42:43], v30 offset:50176
    s_waitcnt lgkmcnt(8)
    v_mfma_f32_32x32x16_bf16 v[96:111], v[56:59], v[204:207], v[96:111]
    ds_read_b64_tr_b16 v[44:45], v31 offset:49152
    ds_read_b64_tr_b16 v[46:47], v31 offset:50176
    s_waitcnt lgkmcnt(8)
    v_mfma_f32_32x32x16_bf16 v[112:127], v[60:63], v[204:207], v[112:127]
    ds_read_b64_tr_b16 v[48:49], v28 offset:53248
    ds_read_b64_tr_b16 v[50:51], v28 offset:54272
    s_waitcnt lgkmcnt(8)
    v_mfma_f32_32x32x16_bf16 v[64:79], v[32:35], v[208:211], v[64:79]
    ds_read_b64_tr_b16 v[52:53], v29 offset:53248
    ds_read_b64_tr_b16 v[54:55], v29 offset:54272
    s_waitcnt lgkmcnt(8)
    v_mfma_f32_32x32x16_bf16 v[80:95], v[36:39], v[208:211], v[80:95]
    ds_read_b64_tr_b16 v[56:57], v30 offset:53248
    ds_read_b64_tr_b16 v[58:59], v30 offset:54272
    s_waitcnt lgkmcnt(8)
    v_mfma_f32_32x32x16_bf16 v[96:111], v[40:43], v[208:211], v[96:111]
    ds_read_b64_tr_b16 v[60:61], v31 offset:53248
    ds_read_b64_tr_b16 v[62:63], v31 offset:54272
    s_waitcnt lgkmcnt(8)
    v_mfma_f32_32x32x16_bf16 v[112:127], v[44:47], v[208:211], v[112:127]
    ds_read_b64_tr_b16 v[32:33], v28 offset:57344
    ds_read_b64_tr_b16 v[34:35], v28 offset:58368
    s_waitcnt lgkmcnt(8)
    v_mfma_f32_32x32x16_bf16 v[64:79], v[48:51], v[212:215], v[64:79]
    ds_read_b64_tr_b16 v[36:37], v29 offset:57344
    ds_read_b64_tr_b16 v[38:39], v29 offset:58368
    s_waitcnt lgkmcnt(8)
    v_mfma_f32_32x32x16_bf16 v[80:95], v[52:55], v[212:215], v[80:95]
    ds_read_b64_tr_b16 v[40:41], v30 offset:57344
    ds_read_b64_tr_b16 v[42:43], v30 offset:58368
    s_waitcnt lgkmcnt(8)
    v_mfma_f32_32x32x16_bf16 v[96:111], v[56:59], v[212:215], v[96:111]
    ds_read_b64_tr_b16 v[44:45], v31 offset:57344
    ds_read_b64_tr_b16 v[46:47], v31 offset:58368
    s_waitcnt lgkmcnt(8)
    v_mfma_f32_32x32x16_bf16 v[112:127], v[60:63], v[212:215], v[112:127]
    ds_read_b64_tr_b16 v[48:49], v28 offset:61440
    ds_read_b64_tr_b16 v[50:51], v28 offset:62464
    s_waitcnt lgkmcnt(8)
    v_mfma_f32_32x32x16_bf16 v[64:79], v[32:35], v[216:219], v[64:79]
    ds_read_b64_tr_b16 v[52:53], v29 offset:61440
    ds_read_b64_tr_b16 v[54:55], v29 offset:62464
    s_waitcnt lgkmcnt(8)
    v_mfma_f32_32x32x16_bf16 v[80:95], v[36:39], v[216:219], v[80:95]
    ds_read_b64_tr_b16 v[56:57], v30 offset:61440
    ds_read_b64_tr_b16 v[58:59], v30 offset:62464
    s_waitcnt lgkmcnt(8)
    v_mfma_f32_32x32x16_bf16 v[96:111], v[40:43], v[216:219], v[96:111]
    ds_read_b64_tr_b16 v[60:61], v31 offset:61440
    ds_read_b64_tr_b16 v[62:63], v31 offset:62464
    s_waitcnt lgkmcnt(8)
    v_mfma_f32_32x32x16_bf16 v[112:127], v[44:47], v[216:219], v[112:127]
    v_add_u32 v28, 0xfffec000, v28
    v_add_u32 v29, 0xfffec000, v29
    v_add_u32 v30, 0xfffec000, v30
    v_add_u32 v31, 0xfffec000, v31
    ds_read_b64_tr_b16 v[32:33], v28 offset:0
    ds_read_b64_tr_b16 v[34:35], v28 offset:1024
    s_waitcnt lgkmcnt(8)
    v_mfma_f32_32x32x16_bf16 v[64:79], v[48:51], v[220:223], v[64:79]
    ds_read_b64_tr_b16 v[36:37], v29 offset:0
    ds_read_b64_tr_b16 v[38:39], v29 offset:1024
    s_waitcnt lgkmcnt(8)
    v_mfma_f32_32x32x16_bf16 v[80:95], v[52:55], v[220:223], v[80:95]
    ds_read_b64_tr_b16 v[40:41], v30 offset:0
    ds_read_b64_tr_b16 v[42:43], v30 offset:1024
    s_waitcnt lgkmcnt(8)
    v_mfma_f32_32x32x16_bf16 v[96:111], v[56:59], v[220:223], v[96:111]
    ds_read_b64_tr_b16 v[44:45], v31 offset:0
    ds_read_b64_tr_b16 v[46:47], v31 offset:1024
    s_waitcnt lgkmcnt(8)
    v_mfma_f32_32x32x16_bf16 v[112:127], v[60:63], v[220:223], v[112:127]
    ds_read_b64_tr_b16 v[48:49], v28 offset:4096
    ds_read_b64_tr_b16 v[50:51], v28 offset:5120
    s_waitcnt lgkmcnt(8)
    v_mfma_f32_32x32x16_bf16 v[64:79], v[32:35], v[224:227], v[64:79]
    ds_read_b64_tr_b16 v[52:53], v29 offset:4096
    ds_read_b64_tr_b16 v[54:55], v29 offset:5120
    s_waitcnt lgkmcnt(8)
    v_mfma_f32_32x32x16_bf16 v[80:95], v[36:39], v[224:227], v[80:95]
    ds_read_b64_tr_b16 v[56:57], v30 offset:4096
    ds_read_b64_tr_b16 v[58:59], v30 offset:5120
    s_waitcnt lgkmcnt(8)
    v_mfma_f32_32x32x16_bf16 v[96:111], v[40:43], v[224:227], v[96:111]
    ds_read_b64_tr_b16 v[60:61], v31 offset:4096
    ds_read_b64_tr_b16 v[62:63], v31 offset:5120
    s_waitcnt lgkmcnt(8)
    v_mfma_f32_32x32x16_bf16 v[112:127], v[44:47], v[224:227], v[112:127]
    ds_read_b64_tr_b16 v[32:33], v28 offset:8192
    ds_read_b64_tr_b16 v[34:35], v28 offset:9216
    s_waitcnt lgkmcnt(8)
    v_mfma_f32_32x32x16_bf16 v[64:79], v[48:51], v[228:231], v[64:79]
    ds_read_b64_tr_b16 v[36:37], v29 offset:8192
    ds_read_b64_tr_b16 v[38:39], v29 offset:9216
    s_waitcnt lgkmcnt(8)
    v_mfma_f32_32x32x16_bf16 v[80:95], v[52:55], v[228:231], v[80:95]
    ds_read_b64_tr_b16 v[40:41], v30 offset:8192
    ds_read_b64_tr_b16 v[42:43], v30 offset:9216
    s_waitcnt lgkmcnt(8)
    v_mfma_f32_32x32x16_bf16 v[96:111], v[56:59], v[228:231], v[96:111]
    ds_read_b64_tr_b16 v[44:45], v31 offset:8192
    ds_read_b64_tr_b16 v[46:47], v31 offset:9216
    s_waitcnt lgkmcnt(8)
    v_mfma_f32_32x32x16_bf16 v[112:127], v[60:63], v[228:231], v[112:127]
    ds_read_b64_tr_b16 v[48:49], v28 offset:12288
    ds_read_b64_tr_b16 v[50:51], v28 offset:13312
    s_waitcnt lgkmcnt(8)
    v_mfma_f32_32x32x16_bf16 v[64:79], v[32:35], v[232:235], v[64:79]
    ds_read_b64_tr_b16 v[52:53], v29 offset:12288
    ds_read_b64_tr_b16 v[54:55], v29 offset:13312
    s_waitcnt lgkmcnt(8)
    v_mfma_f32_32x32x16_bf16 v[80:95], v[36:39], v[232:235], v[80:95]
    ds_read_b64_tr_b16 v[56:57], v30 offset:12288
    ds_read_b64_tr_b16 v[58:59], v30 offset:13312
    s_waitcnt lgkmcnt(8)
    v_mfma_f32_32x32x16_bf16 v[96:111], v[40:43], v[232:235], v[96:111]
    ds_read_b64_tr_b16 v[60:61], v31 offset:12288
    ds_read_b64_tr_b16 v[62:63], v31 offset:13312
    s_waitcnt lgkmcnt(8)
    v_mfma_f32_32x32x16_bf16 v[112:127], v[44:47], v[232:235], v[112:127]
    s_waitcnt lgkmcnt(6)
    v_mfma_f32_32x32x16_bf16 v[64:79], v[48:51], v[236:239], v[64:79]
    s_waitcnt lgkmcnt(4)
    v_mfma_f32_32x32x16_bf16 v[80:95], v[52:55], v[236:239], v[80:95]
    s_waitcnt lgkmcnt(2)
    v_mfma_f32_32x32x16_bf16 v[96:111], v[56:59], v[236:239], v[96:111]
    s_waitcnt lgkmcnt(0)
    v_mfma_f32_32x32x16_bf16 v[112:127], v[60:63], v[236:239], v[112:127]
    s_waitcnt vmcnt(0) lgkmcnt(0)
    s_barrier
    ds_read_b128 v[128:131], v14 offset:0
    ds_read_b128 v[132:135], v14 offset:1024
    ds_read_b128 v[136:139], v14 offset:2048
    ds_read_b128 v[140:143], v14 offset:3072
    ds_read_b128 v[144:147], v14 offset:4096
    ds_read_b128 v[148:151], v14 offset:5120
    ds_read_b128 v[152:155], v14 offset:6144
    ds_read_b128 v[156:159], v14 offset:7168
    ds_read_b64_tr_b16 v[32:33], v28 offset:16384
    ds_read_b64_tr_b16 v[34:35], v28 offset:17408
    ds_read_b64_tr_b16 v[36:37], v29 offset:16384
    ds_read_b64_tr_b16 v[38:39], v29 offset:17408
    ds_read_b64_tr_b16 v[40:41], v30 offset:16384
    ds_read_b64_tr_b16 v[42:43], v30 offset:17408
    ds_read_b64_tr_b16 v[44:45], v31 offset:16384
    ds_read_b64_tr_b16 v[46:47], v31 offset:17408
    ds_read_b64_tr_b16 v[48:49], v28 offset:20480
    ds_read_b64_tr_b16 v[50:51], v28 offset:21504
    s_waitcnt lgkmcnt(8)
    v_mfma_f32_32x32x16_bf16 v[64:79], v[32:35], v[240:243], v[64:79]
    ds_read_b64_tr_b16 v[52:53], v29 offset:20480
    ds_read_b64_tr_b16 v[54:55], v29 offset:21504
    s_xor_b32 s42, s94, 1
    s_lshl_b32 s42, s42, 17
    s_add_u32 s41, s47, s42
    s_add_u32 m0, s50, 0x20000
    s_nop 0
    buffer_load_dwordx4 v22, s[28:31], s41 offen offset:0 lds
    s_waitcnt lgkmcnt(8)
    v_mfma_f32_32x32x16_bf16 v[80:95], v[36:39], v[240:243], v[80:95]
    ds_read_b64_tr_b16 v[56:57], v30 offset:20480
    ds_read_b64_tr_b16 v[58:59], v30 offset:21504
    s_add_u32 s41, s41, 0xc00
    buffer_load_dwordx4 v22, s[28:31], s41 offen offset:1024 lds
    s_waitcnt lgkmcnt(8)
    v_mfma_f32_32x32x16_bf16 v[96:111], v[40:43], v[240:243], v[96:111]
    ds_read_b64_tr_b16 v[60:61], v31 offset:20480
    ds_read_b64_tr_b16 v[62:63], v31 offset:21504
    s_add_u32 s41, s41, 0xc00
    buffer_load_dwordx4 v22, s[28:31], s41 offen offset:2048 lds
    s_waitcnt lgkmcnt(8)
    v_mfma_f32_32x32x16_bf16 v[112:127], v[44:47], v[240:243], v[112:127]
    ds_read_b64_tr_b16 v[32:33], v28 offset:24576
    ds_read_b64_tr_b16 v[34:35], v28 offset:25600
    s_waitcnt lgkmcnt(8)
    v_mfma_f32_32x32x16_bf16 v[64:79], v[48:51], v[244:247], v[64:79]
    ds_read_b64_tr_b16 v[36:37], v29 offset:24576
    ds_read_b64_tr_b16 v[38:39], v29 offset:25600
    s_add_u32 s41, s41, 0xc00
    buffer_load_dwordx4 v22, s[28:31], s41 offen offset:3072 lds
    s_waitcnt lgkmcnt(8)
    v_mfma_f32_32x32x16_bf16 v[80:95], v[52:55], v[244:247], v[80:95]
    ds_read_b64_tr_b16 v[40:41], v30 offset:24576
    ds_read_b64_tr_b16 v[42:43], v30 offset:25600
    s_xor_b32 s42, s94, 1
    s_lshl_b32 s42, s42, 17
    s_add_u32 s41, s47, s42
    s_add_u32 s41, s41, 0x10000
    s_add_u32 m0, s50, 0x24000
    s_nop 0
    buffer_load_dwordx4 v22, s[28:31], s41 offen offset:0 lds
    s_waitcnt lgkmcnt(8)
    v_mfma_f32_32x32x16_bf16 v[96:111], v[56:59], v[244:247], v[96:111]
    ds_read_b64_tr_b16 v[44:45], v31 offset:24576
    ds_read_b64_tr_b16 v[46:47], v31 offset:25600
    s_add_u32 s41, s41, 0xc00
    buffer_load_dwordx4 v22, s[28:31], s41 offen offset:1024 lds
    s_waitcnt lgkmcnt(8)
    v_mfma_f32_32x32x16_bf16 v[112:127], v[60:63], v[244:247], v[112:127]
    ds_read_b64_tr_b16 v[48:49], v28 offset:28672
    ds_read_b64_tr_b16 v[50:51], v28 offset:29696
    s_waitcnt lgkmcnt(8)
    v_mfma_f32_32x32x16_bf16 v[64:79], v[32:35], v[248:251], v[64:79]
    ds_read_b64_tr_b16 v[52:53], v29 offset:28672
    ds_read_b64_tr_b16 v[54:55], v29 offset:29696
    s_add_u32 s41, s41, 0xc00
    buffer_load_dwordx4 v22, s[28:31], s41 offen offset:2048 lds
    s_waitcnt lgkmcnt(8)
    v_mfma_f32_32x32x16_bf16 v[80:95], v[36:39], v[248:251], v[80:95]
    ds_read_b64_tr_b16 v[56:57], v30 offset:28672
    ds_read_b64_tr_b16 v[58:59], v30 offset:29696
    s_add_u32 s41, s41, 0xc00
    buffer_load_dwordx4 v22, s[28:31], s41 offen offset:3072 lds
    s_waitcnt lgkmcnt(8)
    v_mfma_f32_32x32x16_bf16 v[96:111], v[40:43], v[248:251], v[96:111]
    ds_read_b64_tr_b16 v[60:61], v31 offset:28672
    ds_read_b64_tr_b16 v[62:63], v31 offset:29696
    s_xor_b32 s42, s95, 1
    s_lshl_b32 s42, s42, 17
    s_add_u32 s41, s47, s42
    s_add_u32 m0, s50, 0x4000
    s_nop 0
    buffer_load_dwordx4 v22, s[28:31], s41 offen offset:0 lds
    s_waitcnt lgkmcnt(8)
    v_mfma_f32_32x32x16_bf16 v[112:127], v[44:47], v[248:251], v[112:127]
    s_waitcnt lgkmcnt(6)
    v_mfma_f32_32x32x16_bf16 v[64:79], v[48:51], v[252:255], v[64:79]
    s_add_u32 s41, s41, 0xc00
    buffer_load_dwordx4 v22, s[28:31], s41 offen offset:1024 lds
    s_waitcnt lgkmcnt(4)
    v_mfma_f32_32x32x16_bf16 v[80:95], v[52:55], v[252:255], v[80:95]
    s_add_u32 s41, s41, 0xc00
    buffer_load_dwordx4 v22, s[28:31], s41 offen offset:2048 lds
    s_waitcnt lgkmcnt(2)
    v_mfma_f32_32x32x16_bf16 v[96:111], v[56:59], v[252:255], v[96:111]
    s_add_u32 s41, s41, 0xc00
    buffer_load_dwordx4 v22, s[28:31], s41 offen offset:3072 lds
    s_waitcnt lgkmcnt(0)
    v_mfma_f32_32x32x16_bf16 v[112:127], v[60:63], v[252:255], v[112:127]
    s_waitcnt vmcnt(0) lgkmcnt(0)
    s_barrier
    ds_read_b64_tr_b16 v[32:33], v29 offset:49152
    ds_read_b64_tr_b16 v[34:35], v29 offset:50176
    ds_read_b64_tr_b16 v[36:37], v30 offset:49152
    ds_read_b64_tr_b16 v[38:39], v30 offset:50176
    ds_read_b64_tr_b16 v[40:41], v31 offset:49152
    ds_read_b64_tr_b16 v[42:43], v31 offset:50176
    ds_read_b64_tr_b16 v[44:45], v29 offset:53248
    ds_read_b64_tr_b16 v[46:47], v29 offset:54272
    ds_read_b64_tr_b16 v[48:49], v30 offset:53248
    ds_read_b64_tr_b16 v[50:51], v30 offset:54272
    s_waitcnt lgkmcnt(8)
    v_mfma_f32_32x32x16_bf16 v[80:95], v[32:35], v[128:131], v[80:95]
    ds_read_b64_tr_b16 v[52:53], v31 offset:53248
    ds_read_b64_tr_b16 v[54:55], v31 offset:54272
    s_xor_b32 s42, s93, 1
    s_lshl_b32 s42, s42, 13
    s_add_u32 s41, s75, s42
    buffer_load_dwordx4 v[160:163], v7, s[24:27], s41 offen offset:0 sc1
    buffer_load_dwordx4 v[164:167], v7, s[24:27], s41 offen offset:1024 sc1
    s_waitcnt lgkmcnt(8)
    v_mfma_f32_32x32x16_bf16 v[96:111], v[36:39], v[128:131], v[96:111]
    ds_read_b64_tr_b16 v[56:57], v29 offset:57344
    ds_read_b64_tr_b16 v[58:59], v29 offset:58368
    buffer_load_dwordx4 v[168:171], v7, s[24:27], s41 offen offset:2048 sc1
    s_waitcnt lgkmcnt(8)
    v_mfma_f32_32x32x16_bf16 v[112:127], v[40:43], v[128:131], v[112:127]
    ds_read_b64_tr_b16 v[60:61], v30 offset:57344
    ds_read_b64_tr_b16 v[62:63], v30 offset:58368
    buffer_load_dwordx4 v[172:175], v7, s[24:27], s41 offen offset:3072 sc1
    s_waitcnt lgkmcnt(8)
    v_mfma_f32_32x32x16_bf16 v[80:95], v[44:47], v[132:135], v[80:95]
    ds_read_b64_tr_b16 v[32:33], v31 offset:57344
    ds_read_b64_tr_b16 v[34:35], v31 offset:58368
    s_add_u32 s41, s41, 4096
    buffer_load_dwordx4 v[176:179], v7, s[24:27], s41 offen offset:0 sc1
    s_waitcnt lgkmcnt(8)
    v_mfma_f32_32x32x16_bf16 v[96:111], v[48:51], v[132:135], v[96:111]
    ds_read_b64_tr_b16 v[36:37], v29 offset:61440
    ds_read_b64_tr_b16 v[38:39], v29 offset:62464
    buffer_load_dwordx4 v[180:183], v7, s[24:27], s41 offen offset:1024 sc1
    s_waitcnt lgkmcnt(8)
    v_mfma_f32_32x32x16_bf16 v[112:127], v[52:55], v[132:135], v[112:127]
    ds_read_b64_tr_b16 v[40:41], v30 offset:61440
    ds_read_b64_tr_b16 v[42:43], v30 offset:62464
    buffer_load_dwordx4 v[184:187], v7, s[24:27], s41 offen offset:2048 sc1
    s_waitcnt lgkmcnt(8)
    v_mfma_f32_32x32x16_bf16 v[80:95], v[56:59], v[136:139], v[80:95]
    ds_read_b64_tr_b16 v[44:45], v31 offset:61440
    ds_read_b64_tr_b16 v[46:47], v31 offset:62464
    buffer_load_dwordx4 v[188:191], v7, s[24:27], s41 offen offset:3072 sc1
    s_xor_b32 s42, s94, 1
    s_lshl_b32 s42, s42, 13
    s_add_u32 s41, s75, s42
    buffer_load_dwordx4 v[192:195], v7, s[24:27], s41 offen offset:0 sc1
    s_waitcnt lgkmcnt(8)
    v_mfma_f32_32x32x16_bf16 v[96:111], v[60:63], v[136:139], v[96:111]
    v_add_u32 v28, 0x14000, v28
    v_add_u32 v29, 0x14000, v29
    v_add_u32 v30, 0x14000, v30
    v_add_u32 v31, 0x14000, v31
    ds_read_b64_tr_b16 v[48:49], v29 offset:0
    ds_read_b64_tr_b16 v[50:51], v29 offset:1024
    buffer_load_dwordx4 v[196:199], v7, s[24:27], s41 offen offset:1024 sc1
    s_waitcnt lgkmcnt(8)
    v_mfma_f32_32x32x16_bf16 v[112:127], v[32:35], v[136:139], v[112:127]
    ds_read_b64_tr_b16 v[52:53], v30 offset:0
    ds_read_b64_tr_b16 v[54:55], v30 offset:1024
    buffer_load_dwordx4 v[200:203], v7, s[24:27], s41 offen offset:2048 sc1
    s_waitcnt lgkmcnt(8)
    v_mfma_f32_32x32x16_bf16 v[80:95], v[36:39], v[140:143], v[80:95]
    ds_read_b64_tr_b16 v[56:57], v31 offset:0
    ds_read_b64_tr_b16 v[58:59], v31 offset:1024
    buffer_load_dwordx4 v[204:207], v7, s[24:27], s41 offen offset:3072 sc1
    s_waitcnt lgkmcnt(8)
    v_mfma_f32_32x32x16_bf16 v[96:111], v[40:43], v[140:143], v[96:111]
    ds_read_b64_tr_b16 v[60:61], v29 offset:4096
    ds_read_b64_tr_b16 v[62:63], v29 offset:5120
    s_add_u32 s41, s41, 4096
    buffer_load_dwordx4 v[208:211], v7, s[24:27], s41 offen offset:0 sc1
    s_waitcnt lgkmcnt(8)
    v_mfma_f32_32x32x16_bf16 v[112:127], v[44:47], v[140:143], v[112:127]
    ds_read_b64_tr_b16 v[32:33], v30 offset:4096
    ds_read_b64_tr_b16 v[34:35], v30 offset:5120
    buffer_load_dwordx4 v[212:215], v7, s[24:27], s41 offen offset:1024 sc1
    s_waitcnt lgkmcnt(8)
    v_mfma_f32_32x32x16_bf16 v[80:95], v[48:51], v[144:147], v[80:95]
    ds_read_b64_tr_b16 v[36:37], v31 offset:4096
    ds_read_b64_tr_b16 v[38:39], v31 offset:5120
    buffer_load_dwordx4 v[216:219], v7, s[24:27], s41 offen offset:2048 sc1
    buffer_load_dwordx4 v[220:223], v7, s[24:27], s41 offen offset:3072 sc1
    s_waitcnt lgkmcnt(8)
    v_mfma_f32_32x32x16_bf16 v[96:111], v[52:55], v[144:147], v[96:111]
    ds_read_b64_tr_b16 v[40:41], v29 offset:8192
    ds_read_b64_tr_b16 v[42:43], v29 offset:9216
    s_xor_b32 s42, s95, 1
    s_lshl_b32 s42, s42, 13
    s_add_u32 s41, s75, s42
    buffer_load_dwordx4 v[224:227], v7, s[24:27], s41 offen offset:0 sc1
    s_waitcnt lgkmcnt(8)
    v_mfma_f32_32x32x16_bf16 v[112:127], v[56:59], v[144:147], v[112:127]
    ds_read_b64_tr_b16 v[44:45], v30 offset:8192
    ds_read_b64_tr_b16 v[46:47], v30 offset:9216
    buffer_load_dwordx4 v[228:231], v7, s[24:27], s41 offen offset:1024 sc1
    s_waitcnt lgkmcnt(8)
    v_mfma_f32_32x32x16_bf16 v[80:95], v[60:63], v[148:151], v[80:95]
    ds_read_b64_tr_b16 v[48:49], v31 offset:8192
    ds_read_b64_tr_b16 v[50:51], v31 offset:9216
    buffer_load_dwordx4 v[232:235], v7, s[24:27], s41 offen offset:2048 sc1
    s_waitcnt lgkmcnt(8)
    v_mfma_f32_32x32x16_bf16 v[96:111], v[32:35], v[148:151], v[96:111]
    ds_read_b64_tr_b16 v[52:53], v29 offset:12288
    ds_read_b64_tr_b16 v[54:55], v29 offset:13312
    buffer_load_dwordx4 v[236:239], v7, s[24:27], s41 offen offset:3072 sc1
    s_waitcnt lgkmcnt(8)
    v_mfma_f32_32x32x16_bf16 v[112:127], v[36:39], v[148:151], v[112:127]
    ds_read_b64_tr_b16 v[56:57], v30 offset:12288
    ds_read_b64_tr_b16 v[58:59], v30 offset:13312
    s_add_u32 s41, s41, 4096
    buffer_load_dwordx4 v[240:243], v7, s[24:27], s41 offen offset:0 sc1
    s_waitcnt lgkmcnt(8)
    v_mfma_f32_32x32x16_bf16 v[80:95], v[40:43], v[152:155], v[80:95]
    ds_read_b64_tr_b16 v[60:61], v31 offset:12288
    ds_read_b64_tr_b16 v[62:63], v31 offset:13312
    buffer_load_dwordx4 v[244:247], v7, s[24:27], s41 offen offset:1024 sc1
    buffer_load_dwordx4 v[248:251], v7, s[24:27], s41 offen offset:2048 sc1
    s_waitcnt lgkmcnt(8)
    v_mfma_f32_32x32x16_bf16 v[96:111], v[44:47], v[152:155], v[96:111]
    buffer_load_dwordx4 v[252:255], v7, s[24:27], s41 offen offset:3072 sc1
    s_waitcnt lgkmcnt(6)
    v_mfma_f32_32x32x16_bf16 v[112:127], v[48:51], v[152:155], v[112:127]
    s_xor_b32 s42, s95, 1
    s_lshl_b32 s42, s42, 17
    s_add_u32 s41, s47, s42
    s_add_u32 s41, s41, 0x10000
    s_add_u32 m0, s50, 0x8000
    s_nop 0
    buffer_load_dwordx4 v22, s[28:31], s41 offen offset:0 lds
    s_waitcnt lgkmcnt(4)
    v_mfma_f32_32x32x16_bf16 v[80:95], v[52:55], v[156:159], v[80:95]
    s_add_u32 s41, s41, 0xc00
    buffer_load_dwordx4 v22, s[28:31], s41 offen offset:1024 lds
    s_waitcnt lgkmcnt(2)
    v_mfma_f32_32x32x16_bf16 v[96:111], v[56:59], v[156:159], v[96:111]
    s_add_u32 s41, s41, 0xc00
    buffer_load_dwordx4 v22, s[28:31], s41 offen offset:2048 lds
    s_waitcnt lgkmcnt(0)
    v_mfma_f32_32x32x16_bf16 v[112:127], v[60:63], v[156:159], v[112:127]
    s_add_u32 s41, s41, 0xc00
    buffer_load_dwordx4 v22, s[28:31], s41 offen offset:3072 lds
    v_add_u32 v28, 0xfffe8000, v28
    v_add_u32 v29, 0xfffe8000, v29
    v_add_u32 v30, 0xfffe8000, v30
    v_add_u32 v31, 0xfffe8000, v31
    ds_read_b64_tr_b16 v[32:33], v29 offset:0
    ds_read_b64_tr_b16 v[34:35], v29 offset:1024
    ds_read_b64_tr_b16 v[36:37], v30 offset:0
    ds_read_b64_tr_b16 v[38:39], v30 offset:1024
    ds_read_b64_tr_b16 v[40:41], v31 offset:0
    ds_read_b64_tr_b16 v[42:43], v31 offset:1024
    ds_read_b64_tr_b16 v[44:45], v29 offset:4096
    ds_read_b64_tr_b16 v[46:47], v29 offset:5120
    ds_read_b64_tr_b16 v[48:49], v30 offset:4096
    ds_read_b64_tr_b16 v[50:51], v30 offset:5120
    s_waitcnt vmcnt(27) lgkmcnt(8)
    v_mfma_f32_32x32x16_bf16 v[80:95], v[32:35], v[160:163], v[80:95]
    ds_read_b64_tr_b16 v[52:53], v31 offset:4096
    ds_read_b64_tr_b16 v[54:55], v31 offset:5120
    s_waitcnt lgkmcnt(8)
    v_mfma_f32_32x32x16_bf16 v[96:111], v[36:39], v[160:163], v[96:111]
    ds_read_b64_tr_b16 v[56:57], v29 offset:8192
    ds_read_b64_tr_b16 v[58:59], v29 offset:9216
    s_waitcnt lgkmcnt(8)
    v_mfma_f32_32x32x16_bf16 v[112:127], v[40:43], v[160:163], v[112:127]
    ds_read_b64_tr_b16 v[60:61], v30 offset:8192
    ds_read_b64_tr_b16 v[62:63], v30 offset:9216
    s_waitcnt vmcnt(26) lgkmcnt(8)
    v_mfma_f32_32x32x16_bf16 v[80:95], v[44:47], v[164:167], v[80:95]
    ds_read_b64_tr_b16 v[32:33], v31 offset:8192
    ds_read_b64_tr_b16 v[34:35], v31 offset:9216
    s_waitcnt lgkmcnt(8)
    v_mfma_f32_32x32x16_bf16 v[96:111], v[48:51], v[164:167], v[96:111]
    ds_read_b64_tr_b16 v[36:37], v29 offset:12288
    ds_read_b64_tr_b16 v[38:39], v29 offset:13312
    s_waitcnt lgkmcnt(8)
    v_mfma_f32_32x32x16_bf16 v[112:127], v[52:55], v[164:167], v[112:127]
    ds_read_b64_tr_b16 v[40:41], v30 offset:12288
    ds_read_b64_tr_b16 v[42:43], v30 offset:13312
    s_waitcnt vmcnt(25) lgkmcnt(8)
    v_mfma_f32_32x32x16_bf16 v[80:95], v[56:59], v[168:171], v[80:95]
    ds_read_b64_tr_b16 v[44:45], v31 offset:12288
    ds_read_b64_tr_b16 v[46:47], v31 offset:13312
    s_waitcnt lgkmcnt(8)
    v_mfma_f32_32x32x16_bf16 v[96:111], v[60:63], v[168:171], v[96:111]
    v_add_u32 v28, 0x14000, v28
    v_add_u32 v29, 0x14000, v29
    v_add_u32 v30, 0x14000, v30
    v_add_u32 v31, 0x14000, v31
    ds_read_b64_tr_b16 v[48:49], v29 offset:0
    ds_read_b64_tr_b16 v[50:51], v29 offset:1024
    s_waitcnt lgkmcnt(8)
    v_mfma_f32_32x32x16_bf16 v[112:127], v[32:35], v[168:171], v[112:127]
    ds_read_b64_tr_b16 v[52:53], v30 offset:0
    ds_read_b64_tr_b16 v[54:55], v30 offset:1024
    s_waitcnt vmcnt(24) lgkmcnt(8)
    v_mfma_f32_32x32x16_bf16 v[80:95], v[36:39], v[172:175], v[80:95]
    ds_read_b64_tr_b16 v[56:57], v31 offset:0
    ds_read_b64_tr_b16 v[58:59], v31 offset:1024
    s_waitcnt lgkmcnt(8)
    v_mfma_f32_32x32x16_bf16 v[96:111], v[40:43], v[172:175], v[96:111]
    ds_read_b64_tr_b16 v[60:61], v29 offset:4096
    ds_read_b64_tr_b16 v[62:63], v29 offset:5120
    s_waitcnt lgkmcnt(8)
    v_mfma_f32_32x32x16_bf16 v[112:127], v[44:47], v[172:175], v[112:127]
    ds_read_b64_tr_b16 v[32:33], v30 offset:4096
    ds_read_b64_tr_b16 v[34:35], v30 offset:5120
    s_waitcnt vmcnt(23) lgkmcnt(8)
    v_mfma_f32_32x32x16_bf16 v[80:95], v[48:51], v[176:179], v[80:95]
    ds_read_b64_tr_b16 v[36:37], v31 offset:4096
    ds_read_b64_tr_b16 v[38:39], v31 offset:5120
    s_waitcnt lgkmcnt(8)
    v_mfma_f32_32x32x16_bf16 v[96:111], v[52:55], v[176:179], v[96:111]
    ds_read_b64_tr_b16 v[40:41], v29 offset:8192
    ds_read_b64_tr_b16 v[42:43], v29 offset:9216
    s_waitcnt lgkmcnt(8)
    v_mfma_f32_32x32x16_bf16 v[112:127], v[56:59], v[176:179], v[112:127]
    ds_read_b64_tr_b16 v[44:45], v30 offset:8192
    ds_read_b64_tr_b16 v[46:47], v30 offset:9216
    s_waitcnt vmcnt(22) lgkmcnt(8)
    v_mfma_f32_32x32x16_bf16 v[80:95], v[60:63], v[180:183], v[80:95]
    ds_read_b64_tr_b16 v[48:49], v31 offset:8192
    ds_read_b64_tr_b16 v[50:51], v31 offset:9216
    s_waitcnt lgkmcnt(8)
    v_mfma_f32_32x32x16_bf16 v[96:111], v[32:35], v[180:183], v[96:111]
    ds_read_b64_tr_b16 v[52:53], v29 offset:12288
    ds_read_b64_tr_b16 v[54:55], v29 offset:13312
    s_waitcnt lgkmcnt(8)
    v_mfma_f32_32x32x16_bf16 v[112:127], v[36:39], v[180:183], v[112:127]
    ds_read_b64_tr_b16 v[56:57], v30 offset:12288
    ds_read_b64_tr_b16 v[58:59], v30 offset:13312
    s_waitcnt vmcnt(21) lgkmcnt(8)
    v_mfma_f32_32x32x16_bf16 v[80:95], v[40:43], v[184:187], v[80:95]
    ds_read_b64_tr_b16 v[60:61], v31 offset:12288
    ds_read_b64_tr_b16 v[62:63], v31 offset:13312
    s_waitcnt lgkmcnt(8)
    v_mfma_f32_32x32x16_bf16 v[96:111], v[44:47], v[184:187], v[96:111]
    ds_read_b64_tr_b16 v[32:33], v29 offset:49152
    ds_read_b64_tr_b16 v[34:35], v29 offset:50176
    s_waitcnt lgkmcnt(8)
    v_mfma_f32_32x32x16_bf16 v[112:127], v[48:51], v[184:187], v[112:127]
    ds_read_b64_tr_b16 v[36:37], v30 offset:49152
    ds_read_b64_tr_b16 v[38:39], v30 offset:50176
    s_waitcnt vmcnt(20) lgkmcnt(8)
    v_mfma_f32_32x32x16_bf16 v[80:95], v[52:55], v[188:191], v[80:95]
    ds_read_b64_tr_b16 v[40:41], v31 offset:49152
    ds_read_b64_tr_b16 v[42:43], v31 offset:50176
    s_waitcnt lgkmcnt(8)
    v_mfma_f32_32x32x16_bf16 v[96:111], v[56:59], v[188:191], v[96:111]
    ds_read_b64_tr_b16 v[44:45], v29 offset:53248
    ds_read_b64_tr_b16 v[46:47], v29 offset:54272
    s_waitcnt lgkmcnt(8)
    v_mfma_f32_32x32x16_bf16 v[112:127], v[60:63], v[188:191], v[112:127]
    ds_read_b64_tr_b16 v[48:49], v30 offset:53248
    ds_read_b64_tr_b16 v[50:51], v30 offset:54272
    s_waitcnt vmcnt(19) lgkmcnt(8)
    v_mfma_f32_32x32x16_bf16 v[80:95], v[32:35], v[192:195], v[80:95]
    ds_read_b64_tr_b16 v[52:53], v31 offset:53248
    ds_read_b64_tr_b16 v[54:55], v31 offset:54272
    s_waitcnt lgkmcnt(8)
    v_mfma_f32_32x32x16_bf16 v[96:111], v[36:39], v[192:195], v[96:111]
    ds_read_b64_tr_b16 v[56:57], v29 offset:57344
    ds_read_b64_tr_b16 v[58:59], v29 offset:58368
    s_waitcnt lgkmcnt(8)
    v_mfma_f32_32x32x16_bf16 v[112:127], v[40:43], v[192:195], v[112:127]
    ds_read_b64_tr_b16 v[60:61], v30 offset:57344
    ds_read_b64_tr_b16 v[62:63], v30 offset:58368
    s_waitcnt vmcnt(18) lgkmcnt(8)
    v_mfma_f32_32x32x16_bf16 v[80:95], v[44:47], v[196:199], v[80:95]
    ds_read_b64_tr_b16 v[32:33], v31 offset:57344
    ds_read_b64_tr_b16 v[34:35], v31 offset:58368
    s_waitcnt lgkmcnt(8)
    v_mfma_f32_32x32x16_bf16 v[96:111], v[48:51], v[196:199], v[96:111]
    ds_read_b64_tr_b16 v[36:37], v29 offset:61440
    ds_read_b64_tr_b16 v[38:39], v29 offset:62464
    s_waitcnt lgkmcnt(8)
    v_mfma_f32_32x32x16_bf16 v[112:127], v[52:55], v[196:199], v[112:127]
    ds_read_b64_tr_b16 v[40:41], v30 offset:61440
    ds_read_b64_tr_b16 v[42:43], v30 offset:62464
    s_waitcnt vmcnt(17) lgkmcnt(8)
    v_mfma_f32_32x32x16_bf16 v[80:95], v[56:59], v[200:203], v[80:95]
    ds_read_b64_tr_b16 v[44:45], v31 offset:61440
    ds_read_b64_tr_b16 v[46:47], v31 offset:62464
    s_waitcnt lgkmcnt(8)
    v_mfma_f32_32x32x16_bf16 v[96:111], v[60:63], v[200:203], v[96:111]
    v_add_u32 v28, 0x10000, v28
    v_add_u32 v29, 0x10000, v29
    v_add_u32 v30, 0x10000, v30
    v_add_u32 v31, 0x10000, v31
    ds_read_b64_tr_b16 v[48:49], v29 offset:0
    ds_read_b64_tr_b16 v[50:51], v29 offset:1024
    s_waitcnt lgkmcnt(8)
    v_mfma_f32_32x32x16_bf16 v[112:127], v[32:35], v[200:203], v[112:127]
    ds_read_b64_tr_b16 v[52:53], v30 offset:0
    ds_read_b64_tr_b16 v[54:55], v30 offset:1024
    s_waitcnt vmcnt(16) lgkmcnt(8)
    v_mfma_f32_32x32x16_bf16 v[80:95], v[36:39], v[204:207], v[80:95]
    ds_read_b64_tr_b16 v[56:57], v31 offset:0
    ds_read_b64_tr_b16 v[58:59], v31 offset:1024
    s_waitcnt lgkmcnt(8)
    v_mfma_f32_32x32x16_bf16 v[96:111], v[40:43], v[204:207], v[96:111]
    ds_read_b64_tr_b16 v[60:61], v29 offset:4096
    ds_read_b64_tr_b16 v[62:63], v29 offset:5120
    s_waitcnt lgkmcnt(8)
    v_mfma_f32_32x32x16_bf16 v[112:127], v[44:47], v[204:207], v[112:127]
    ds_read_b64_tr_b16 v[32:33], v30 offset:4096
    ds_read_b64_tr_b16 v[34:35], v30 offset:5120
    s_waitcnt vmcnt(15) lgkmcnt(8)
    v_mfma_f32_32x32x16_bf16 v[80:95], v[48:51], v[208:211], v[80:95]
    ds_read_b64_tr_b16 v[36:37], v31 offset:4096
    ds_read_b64_tr_b16 v[38:39], v31 offset:5120
    s_waitcnt lgkmcnt(8)
    v_mfma_f32_32x32x16_bf16 v[96:111], v[52:55], v[208:211], v[96:111]
    ds_read_b64_tr_b16 v[40:41], v29 offset:8192
    ds_read_b64_tr_b16 v[42:43], v29 offset:9216
    s_waitcnt lgkmcnt(8)
    v_mfma_f32_32x32x16_bf16 v[112:127], v[56:59], v[208:211], v[112:127]
    ds_read_b64_tr_b16 v[44:45], v30 offset:8192
    ds_read_b64_tr_b16 v[46:47], v30 offset:9216
    s_waitcnt vmcnt(14) lgkmcnt(8)
    v_mfma_f32_32x32x16_bf16 v[80:95], v[60:63], v[212:215], v[80:95]
    ds_read_b64_tr_b16 v[48:49], v31 offset:8192
    ds_read_b64_tr_b16 v[50:51], v31 offset:9216
    s_waitcnt lgkmcnt(8)
    v_mfma_f32_32x32x16_bf16 v[96:111], v[32:35], v[212:215], v[96:111]
    ds_read_b64_tr_b16 v[52:53], v29 offset:12288
    ds_read_b64_tr_b16 v[54:55], v29 offset:13312
    s_waitcnt lgkmcnt(8)
    v_mfma_f32_32x32x16_bf16 v[112:127], v[36:39], v[212:215], v[112:127]
    ds_read_b64_tr_b16 v[56:57], v30 offset:12288
    ds_read_b64_tr_b16 v[58:59], v30 offset:13312
    s_waitcnt vmcnt(13) lgkmcnt(8)
    v_mfma_f32_32x32x16_bf16 v[80:95], v[40:43], v[216:219], v[80:95]
    ds_read_b64_tr_b16 v[60:61], v31 offset:12288
    ds_read_b64_tr_b16 v[62:63], v31 offset:13312
    s_waitcnt lgkmcnt(8)
    v_mfma_f32_32x32x16_bf16 v[96:111], v[44:47], v[216:219], v[96:111]
    v_add_u32 v28, 0xfffe0000, v28
    v_add_u32 v29, 0xfffe0000, v29
    v_add_u32 v30, 0xfffe0000, v30
    v_add_u32 v31, 0xfffe0000, v31
    ds_read_b64_tr_b16 v[32:33], v29 offset:0
    ds_read_b64_tr_b16 v[34:35], v29 offset:1024
    s_waitcnt lgkmcnt(8)
    v_mfma_f32_32x32x16_bf16 v[112:127], v[48:51], v[216:219], v[112:127]
    ds_read_b64_tr_b16 v[36:37], v30 offset:0
    ds_read_b64_tr_b16 v[38:39], v30 offset:1024
    s_waitcnt vmcnt(12) lgkmcnt(8)
    v_mfma_f32_32x32x16_bf16 v[80:95], v[52:55], v[220:223], v[80:95]
    ds_read_b64_tr_b16 v[40:41], v31 offset:0
    ds_read_b64_tr_b16 v[42:43], v31 offset:1024
    s_waitcnt lgkmcnt(8)
    v_mfma_f32_32x32x16_bf16 v[96:111], v[56:59], v[220:223], v[96:111]
    ds_read_b64_tr_b16 v[44:45], v29 offset:4096
    ds_read_b64_tr_b16 v[46:47], v29 offset:5120
    s_waitcnt lgkmcnt(8)
    v_mfma_f32_32x32x16_bf16 v[112:127], v[60:63], v[220:223], v[112:127]
    ds_read_b64_tr_b16 v[48:49], v30 offset:4096
    ds_read_b64_tr_b16 v[50:51], v30 offset:5120
    s_waitcnt vmcnt(11) lgkmcnt(8)
    v_mfma_f32_32x32x16_bf16 v[80:95], v[32:35], v[224:227], v[80:95]
    ds_read_b64_tr_b16 v[52:53], v31 offset:4096
    ds_read_b64_tr_b16 v[54:55], v31 offset:5120
    s_waitcnt lgkmcnt(8)
    v_mfma_f32_32x32x16_bf16 v[96:111], v[36:39], v[224:227], v[96:111]
    ds_read_b64_tr_b16 v[56:57], v29 offset:8192
    ds_read_b64_tr_b16 v[58:59], v29 offset:9216
    s_waitcnt lgkmcnt(8)
    v_mfma_f32_32x32x16_bf16 v[112:127], v[40:43], v[224:227], v[112:127]
    ds_read_b64_tr_b16 v[60:61], v30 offset:8192
    ds_read_b64_tr_b16 v[62:63], v30 offset:9216
    s_waitcnt vmcnt(10) lgkmcnt(8)
    v_mfma_f32_32x32x16_bf16 v[80:95], v[44:47], v[228:231], v[80:95]
    ds_read_b64_tr_b16 v[32:33], v31 offset:8192
    ds_read_b64_tr_b16 v[34:35], v31 offset:9216
    s_waitcnt lgkmcnt(8)
    v_mfma_f32_32x32x16_bf16 v[96:111], v[48:51], v[228:231], v[96:111]
    ds_read_b64_tr_b16 v[36:37], v29 offset:12288
    ds_read_b64_tr_b16 v[38:39], v29 offset:13312
    s_waitcnt lgkmcnt(8)
    v_mfma_f32_32x32x16_bf16 v[112:127], v[52:55], v[228:231], v[112:127]
    ds_read_b64_tr_b16 v[40:41], v30 offset:12288
    ds_read_b64_tr_b16 v[42:43], v30 offset:13312
    s_waitcnt vmcnt(9) lgkmcnt(8)
    v_mfma_f32_32x32x16_bf16 v[80:95], v[56:59], v[232:235], v[80:95]
    ds_read_b64_tr_b16 v[44:45], v31 offset:12288
    ds_read_b64_tr_b16 v[46:47], v31 offset:13312
    s_waitcnt lgkmcnt(8)
    v_mfma_f32_32x32x16_bf16 v[96:111], v[60:63], v[232:235], v[96:111]
    s_waitcnt lgkmcnt(6)
    v_mfma_f32_32x32x16_bf16 v[112:127], v[32:35], v[232:235], v[112:127]
    s_waitcnt vmcnt(8) lgkmcnt(4)
    v_mfma_f32_32x32x16_bf16 v[80:95], v[36:39], v[236:239], v[80:95]
    s_waitcnt lgkmcnt(2)
    v_mfma_f32_32x32x16_bf16 v[96:111], v[40:43], v[236:239], v[96:111]
    s_waitcnt lgkmcnt(0)
    v_mfma_f32_32x32x16_bf16 v[112:127], v[44:47], v[236:239], v[112:127]
    s_waitcnt vmcnt(0)
    s_barrier
    ds_read_b64_tr_b16 v[32:33], v29 offset:16384
    ds_read_b64_tr_b16 v[34:35], v29 offset:17408
    ds_read_b64_tr_b16 v[36:37], v30 offset:16384
    ds_read_b64_tr_b16 v[38:39], v30 offset:17408
    ds_read_b64_tr_b16 v[40:41], v31 offset:16384
    ds_read_b64_tr_b16 v[42:43], v31 offset:17408
    ds_read_b64_tr_b16 v[44:45], v29 offset:20480
    ds_read_b64_tr_b16 v[46:47], v29 offset:21504
    ds_read_b64_tr_b16 v[48:49], v30 offset:20480
    ds_read_b64_tr_b16 v[50:51], v30 offset:21504
    s_waitcnt lgkmcnt(8)
    v_mfma_f32_32x32x16_bf16 v[80:95], v[32:35], v[240:243], v[80:95]
    ds_read_b64_tr_b16 v[52:53], v31 offset:20480
    ds_read_b64_tr_b16 v[54:55], v31 offset:21504
    s_waitcnt lgkmcnt(8)
    v_mfma_f32_32x32x16_bf16 v[96:111], v[36:39], v[240:243], v[96:111]
    ds_read_b64_tr_b16 v[56:57], v29 offset:24576
    ds_read_b64_tr_b16 v[58:59], v29 offset:25600
    s_waitcnt lgkmcnt(8)
    v_mfma_f32_32x32x16_bf16 v[112:127], v[40:43], v[240:243], v[112:127]
    ds_read_b64_tr_b16 v[60:61], v30 offset:24576
    ds_read_b64_tr_b16 v[62:63], v30 offset:25600
    s_waitcnt lgkmcnt(8)
    v_mfma_f32_32x32x16_bf16 v[80:95], v[44:47], v[244:247], v[80:95]
    ds_read_b64_tr_b16 v[32:33], v31 offset:24576
    ds_read_b64_tr_b16 v[34:35], v31 offset:25600
    s_waitcnt lgkmcnt(8)
    v_mfma_f32_32x32x16_bf16 v[96:111], v[48:51], v[244:247], v[96:111]
    ds_read_b64_tr_b16 v[36:37], v29 offset:28672
    ds_read_b64_tr_b16 v[38:39], v29 offset:29696
    s_waitcnt lgkmcnt(8)
    v_mfma_f32_32x32x16_bf16 v[112:127], v[52:55], v[244:247], v[112:127]
    ds_read_b64_tr_b16 v[40:41], v30 offset:28672
    ds_read_b64_tr_b16 v[42:43], v30 offset:29696
    s_waitcnt lgkmcnt(8)
    v_mfma_f32_32x32x16_bf16 v[80:95], v[56:59], v[248:251], v[80:95]
    ds_read_b64_tr_b16 v[44:45], v31 offset:28672
    ds_read_b64_tr_b16 v[46:47], v31 offset:29696
    s_waitcnt lgkmcnt(8)
    v_mfma_f32_32x32x16_bf16 v[96:111], v[60:63], v[248:251], v[96:111]
    s_waitcnt lgkmcnt(6)
    v_mfma_f32_32x32x16_bf16 v[112:127], v[32:35], v[248:251], v[112:127]
    s_waitcnt lgkmcnt(4)
    v_mfma_f32_32x32x16_bf16 v[80:95], v[36:39], v[252:255], v[80:95]
    s_waitcnt lgkmcnt(2)
    v_mfma_f32_32x32x16_bf16 v[96:111], v[40:43], v[252:255], v[96:111]
    s_waitcnt lgkmcnt(0)
    v_mfma_f32_32x32x16_bf16 v[112:127], v[44:47], v[252:255], v[112:127]
    s_lshl_b32 s43, s37, 2
    s_add_u32 s43, s43, s87
    s_mul_i32 s43, s43, 98304
    s_lshl_b32 s41, s36, 11
    s_add_u32 s43, s43, s41
    s_add_u32 s75, s43, 0x2000000
    s_xor_b32 s41, s85, 1
    s_mul_i32 s41, s41, 24576
    s_add_u32 s41, s41, s75
    s_add_u32 s41, s41, 0
    v_cvt_pk_bf16_f32 v80, v80, v81
    v_cvt_pk_bf16_f32 v81, v82, v83
    v_cvt_pk_bf16_f32 v82, v84, v85
    v_cvt_pk_bf16_f32 v83, v86, v87
    buffer_store_dwordx4 v[80:83], v7, s[24:27], s41 offen offset:0 sc1
    v_cvt_pk_bf16_f32 v88, v88, v89
    v_cvt_pk_bf16_f32 v89, v90, v91
    v_cvt_pk_bf16_f32 v90, v92, v93
    v_cvt_pk_bf16_f32 v91, v94, v95
    buffer_store_dwordx4 v[88:91], v7, s[24:27], s41 offen offset:1024 sc1
    s_xor_b32 s41, s85, 2
    s_mul_i32 s41, s41, 24576
    s_add_u32 s41, s41, s75
    s_add_u32 s41, s41, 8192
    v_cvt_pk_bf16_f32 v96, v96, v97
    v_cvt_pk_bf16_f32 v97, v98, v99
    v_cvt_pk_bf16_f32 v98, v100, v101
    v_cvt_pk_bf16_f32 v99, v102, v103
    buffer_store_dwordx4 v[96:99], v7, s[24:27], s41 offen offset:0 sc1
    v_cvt_pk_bf16_f32 v104, v104, v105
    v_cvt_pk_bf16_f32 v105, v106, v107
    v_cvt_pk_bf16_f32 v106, v108, v109
    v_cvt_pk_bf16_f32 v107, v110, v111
    buffer_store_dwordx4 v[104:107], v7, s[24:27], s41 offen offset:1024 sc1
    s_xor_b32 s41, s85, 3
    s_mul_i32 s41, s41, 24576
    s_add_u32 s41, s41, s75
    s_add_u32 s41, s41, 16384
    v_cvt_pk_bf16_f32 v112, v112, v113
    v_cvt_pk_bf16_f32 v113, v114, v115
    v_cvt_pk_bf16_f32 v114, v116, v117
    v_cvt_pk_bf16_f32 v115, v118, v119
    buffer_store_dwordx4 v[112:115], v7, s[24:27], s41 offen offset:0 sc1
    v_cvt_pk_bf16_f32 v120, v120, v121
    v_cvt_pk_bf16_f32 v121, v122, v123
    v_cvt_pk_bf16_f32 v122, v124, v125
    v_cvt_pk_bf16_f32 v123, v126, v127
    buffer_store_dwordx4 v[120:123], v7, s[24:27], s41 offen offset:1024 sc1
    ds_read_b64_tr_b16 v[32:33], v28 offset:49152
    ds_read_b64_tr_b16 v[34:35], v28 offset:50176
    ds_read_b64_tr_b16 v[36:37], v28 offset:53248
    ds_read_b64_tr_b16 v[38:39], v28 offset:54272
    ds_read_b64_tr_b16 v[40:41], v28 offset:57344
    ds_read_b64_tr_b16 v[42:43], v28 offset:58368
    ds_read_b64_tr_b16 v[44:45], v28 offset:61440
    ds_read_b64_tr_b16 v[46:47], v28 offset:62464
    v_add_u32 v28, 0x14000, v28
    v_add_u32 v29, 0x14000, v29
    v_add_u32 v30, 0x14000, v30
    v_add_u32 v31, 0x14000, v31
    ds_read_b64_tr_b16 v[48:49], v28 offset:0
    ds_read_b64_tr_b16 v[50:51], v28 offset:1024
    s_waitcnt lgkmcnt(8)
    v_mfma_f32_32x32x16_bf16 v[64:79], v[32:35], v[128:131], v[64:79]
    ds_read_b64_tr_b16 v[52:53], v28 offset:4096
    ds_read_b64_tr_b16 v[54:55], v28 offset:5120
    s_waitcnt lgkmcnt(8)
    v_mfma_f32_32x32x16_bf16 v[64:79], v[36:39], v[132:135], v[64:79]
    ds_read_b64_tr_b16 v[56:57], v28 offset:8192
    ds_read_b64_tr_b16 v[58:59], v28 offset:9216
    s_waitcnt lgkmcnt(8)
    v_mfma_f32_32x32x16_bf16 v[64:79], v[40:43], v[136:139], v[64:79]
    ds_read_b64_tr_b16 v[60:61], v28 offset:12288
    ds_read_b64_tr_b16 v[62:63], v28 offset:13312
    s_waitcnt lgkmcnt(8)
    v_mfma_f32_32x32x16_bf16 v[64:79], v[44:47], v[140:143], v[64:79]
    v_add_u32 v28, 0xfffe8000, v28
    v_add_u32 v29, 0xfffe8000, v29
    v_add_u32 v30, 0xfffe8000, v30
    v_add_u32 v31, 0xfffe8000, v31
    ds_read_b64_tr_b16 v[32:33], v28 offset:0
    ds_read_b64_tr_b16 v[34:35], v28 offset:1024
    s_waitcnt lgkmcnt(8)
    v_mfma_f32_32x32x16_bf16 v[64:79], v[48:51], v[144:147], v[64:79]
    ds_read_b64_tr_b16 v[36:37], v28 offset:4096
    ds_read_b64_tr_b16 v[38:39], v28 offset:5120
    s_waitcnt lgkmcnt(8)
    v_mfma_f32_32x32x16_bf16 v[64:79], v[52:55], v[148:151], v[64:79]
    ds_read_b64_tr_b16 v[40:41], v28 offset:8192
    ds_read_b64_tr_b16 v[42:43], v28 offset:9216
    s_waitcnt lgkmcnt(8)
    v_mfma_f32_32x32x16_bf16 v[64:79], v[56:59], v[152:155], v[64:79]
    ds_read_b64_tr_b16 v[44:45], v28 offset:12288
    ds_read_b64_tr_b16 v[46:47], v28 offset:13312
    s_waitcnt lgkmcnt(8)
    v_mfma_f32_32x32x16_bf16 v[64:79], v[60:63], v[156:159], v[64:79]
    v_add_u32 v28, 0x14000, v28
    v_add_u32 v29, 0x14000, v29
    v_add_u32 v30, 0x14000, v30
    v_add_u32 v31, 0x14000, v31
    ds_read_b64_tr_b16 v[48:49], v28 offset:0
    ds_read_b64_tr_b16 v[50:51], v28 offset:1024
    s_waitcnt lgkmcnt(8)
    v_mfma_f32_32x32x16_bf16 v[64:79], v[32:35], v[160:163], v[64:79]
    ds_read_b64_tr_b16 v[52:53], v28 offset:4096
    ds_read_b64_tr_b16 v[54:55], v28 offset:5120
    s_waitcnt lgkmcnt(8)
    v_mfma_f32_32x32x16_bf16 v[64:79], v[36:39], v[164:167], v[64:79]
    ds_read_b64_tr_b16 v[56:57], v28 offset:8192
    ds_read_b64_tr_b16 v[58:59], v28 offset:9216
    s_waitcnt lgkmcnt(8)
    v_mfma_f32_32x32x16_bf16 v[64:79], v[40:43], v[168:171], v[64:79]
    ds_read_b64_tr_b16 v[60:61], v28 offset:12288
    ds_read_b64_tr_b16 v[62:63], v28 offset:13312
    s_waitcnt lgkmcnt(8)
    v_mfma_f32_32x32x16_bf16 v[64:79], v[44:47], v[172:175], v[64:79]
    ds_read_b64_tr_b16 v[32:33], v28 offset:49152
    ds_read_b64_tr_b16 v[34:35], v28 offset:50176
    s_waitcnt lgkmcnt(8)
    v_mfma_f32_32x32x16_bf16 v[64:79], v[48:51], v[176:179], v[64:79]
    ds_read_b64_tr_b16 v[36:37], v28 offset:53248
    ds_read_b64_tr_b16 v[38:39], v28 offset:54272
    s_waitcnt lgkmcnt(8)
    v_mfma_f32_32x32x16_bf16 v[64:79], v[52:55], v[180:183], v[64:79]
    ds_read_b64_tr_b16 v[40:41], v28 offset:57344
    ds_read_b64_tr_b16 v[42:43], v28 offset:58368
    s_waitcnt lgkmcnt(8)
    v_mfma_f32_32x32x16_bf16 v[64:79], v[56:59], v[184:187], v[64:79]
    ds_read_b64_tr_b16 v[44:45], v28 offset:61440
    ds_read_b64_tr_b16 v[46:47], v28 offset:62464
    s_waitcnt lgkmcnt(8)
    v_mfma_f32_32x32x16_bf16 v[64:79], v[60:63], v[188:191], v[64:79]
    s_waitcnt lgkmcnt(6)
    v_mfma_f32_32x32x16_bf16 v[64:79], v[32:35], v[192:195], v[64:79]
    s_waitcnt lgkmcnt(4)
    v_mfma_f32_32x32x16_bf16 v[64:79], v[36:39], v[196:199], v[64:79]
    s_waitcnt lgkmcnt(2)
    v_mfma_f32_32x32x16_bf16 v[64:79], v[40:43], v[200:203], v[64:79]
    s_waitcnt lgkmcnt(0)
    v_mfma_f32_32x32x16_bf16 v[64:79], v[44:47], v[204:207], v[64:79]
    s_waitcnt vmcnt(0)
    s_barrier
    v_add_u32 v28, 0x10000, v28
    v_add_u32 v29, 0x10000, v29
    v_add_u32 v30, 0x10000, v30
    v_add_u32 v31, 0x10000, v31
    ds_read_b64_tr_b16 v[32:33], v28 offset:0
    ds_read_b64_tr_b16 v[34:35], v28 offset:1024
    ds_read_b64_tr_b16 v[36:37], v28 offset:4096
    ds_read_b64_tr_b16 v[38:39], v28 offset:5120
    ds_read_b64_tr_b16 v[40:41], v28 offset:8192
    ds_read_b64_tr_b16 v[42:43], v28 offset:9216
    ds_read_b64_tr_b16 v[44:45], v28 offset:12288
    ds_read_b64_tr_b16 v[46:47], v28 offset:13312
    v_add_u32 v28, 0xfffe0000, v28
    v_add_u32 v29, 0xfffe0000, v29
    v_add_u32 v30, 0xfffe0000, v30
    v_add_u32 v31, 0xfffe0000, v31
    ds_read_b64_tr_b16 v[48:49], v28 offset:0
    ds_read_b64_tr_b16 v[50:51], v28 offset:1024
    s_waitcnt lgkmcnt(8)
    v_mfma_f32_32x32x16_bf16 v[64:79], v[32:35], v[208:211], v[64:79]
    ds_read_b64_tr_b16 v[52:53], v28 offset:4096
    ds_read_b64_tr_b16 v[54:55], v28 offset:5120
    s_waitcnt lgkmcnt(8)
    v_mfma_f32_32x32x16_bf16 v[64:79], v[36:39], v[212:215], v[64:79]
    ds_read_b64_tr_b16 v[56:57], v28 offset:8192
    ds_read_b64_tr_b16 v[58:59], v28 offset:9216
    s_waitcnt lgkmcnt(8)
    v_mfma_f32_32x32x16_bf16 v[64:79], v[40:43], v[216:219], v[64:79]
    ds_read_b64_tr_b16 v[60:61], v28 offset:12288
    ds_read_b64_tr_b16 v[62:63], v28 offset:13312
    s_waitcnt lgkmcnt(8)
    v_mfma_f32_32x32x16_bf16 v[64:79], v[44:47], v[220:223], v[64:79]
    ds_read_b64_tr_b16 v[32:33], v28 offset:16384
    ds_read_b64_tr_b16 v[34:35], v28 offset:17408
    s_waitcnt lgkmcnt(8)
    v_mfma_f32_32x32x16_bf16 v[64:79], v[48:51], v[224:227], v[64:79]
    ds_read_b64_tr_b16 v[36:37], v28 offset:20480
    ds_read_b64_tr_b16 v[38:39], v28 offset:21504
    s_waitcnt lgkmcnt(8)
    v_mfma_f32_32x32x16_bf16 v[64:79], v[52:55], v[228:231], v[64:79]
    ds_read_b64_tr_b16 v[40:41], v28 offset:24576
    ds_read_b64_tr_b16 v[42:43], v28 offset:25600
    s_waitcnt lgkmcnt(8)
    v_mfma_f32_32x32x16_bf16 v[64:79], v[56:59], v[232:235], v[64:79]
    ds_read_b64_tr_b16 v[44:45], v28 offset:28672
    ds_read_b64_tr_b16 v[46:47], v28 offset:29696
    s_waitcnt lgkmcnt(8)
    v_mfma_f32_32x32x16_bf16 v[64:79], v[60:63], v[236:239], v[64:79]
    s_waitcnt lgkmcnt(6)
    v_mfma_f32_32x32x16_bf16 v[64:79], v[32:35], v[240:243], v[64:79]
    s_waitcnt lgkmcnt(4)
    v_mfma_f32_32x32x16_bf16 v[64:79], v[36:39], v[244:247], v[64:79]
    s_waitcnt lgkmcnt(2)
    v_mfma_f32_32x32x16_bf16 v[64:79], v[40:43], v[248:251], v[64:79]
    s_waitcnt lgkmcnt(0)
    v_mfma_f32_32x32x16_bf16 v[64:79], v[44:47], v[252:255], v[64:79]
    v_and_b32 v4, 31, v1
    v_lshlrev_b32 v4, 10, v4
    v_lshrrev_b32 v5, 5, v1
    v_lshl_add_u32 v4, v5, 4, v4
    s_lshl_b32 s48, s37, 17
    s_lshl_b32 s41, s36, 15
    s_add_u32 s48, s48, s41
    s_lshl_b32 s41, s87, 8
    s_add_u32 s48, s48, s41
    s_lshl_b32 s41, s85, 6
    s_add_u32 s48, s48, s41
    s_mul_i32 s42, s85, 24576
    s_add_u32 s75, s75, s42
    s_barrier
    buffer_load_dwordx4 v[32:35], v7, s[24:27], s75 offen offset:0 sc1
    buffer_load_dwordx4 v[36:39], v7, s[24:27], s75 offen offset:1024 sc1
    s_add_u32 s75, s75, 8192
    buffer_load_dwordx4 v[40:43], v7, s[24:27], s75 offen offset:0 sc1
    buffer_load_dwordx4 v[44:47], v7, s[24:27], s75 offen offset:1024 sc1
    s_add_u32 s75, s75, 8192
    buffer_load_dwordx4 v[48:51], v7, s[24:27], s75 offen offset:0 sc1
    buffer_load_dwordx4 v[52:55], v7, s[24:27], s75 offen offset:1024 sc1
    s_waitcnt vmcnt(5)
    v_lshlrev_b32 v2, 16, v32
    v_and_b32 v3, 0xffff0000, v32
    v_add_f32 v64, v64, v2
    v_add_f32 v65, v65, v3
    v_lshlrev_b32 v2, 16, v33
    v_and_b32 v3, 0xffff0000, v33
    v_add_f32 v66, v66, v2
    v_add_f32 v67, v67, v3
    v_lshlrev_b32 v2, 16, v34
    v_and_b32 v3, 0xffff0000, v34
    v_add_f32 v68, v68, v2
    v_add_f32 v69, v69, v3
    v_lshlrev_b32 v2, 16, v35
    v_and_b32 v3, 0xffff0000, v35
    v_add_f32 v70, v70, v2
    v_add_f32 v71, v71, v3
    s_waitcnt vmcnt(4)
    v_lshlrev_b32 v2, 16, v36
    v_and_b32 v3, 0xffff0000, v36
    v_add_f32 v72, v72, v2
    v_add_f32 v73, v73, v3
    v_lshlrev_b32 v2, 16, v37
    v_and_b32 v3, 0xffff0000, v37
    v_add_f32 v74, v74, v2
    v_add_f32 v75, v75, v3
    v_lshlrev_b32 v2, 16, v38
    v_and_b32 v3, 0xffff0000, v38
    v_add_f32 v76, v76, v2
    v_add_f32 v77, v77, v3
    v_lshlrev_b32 v2, 16, v39
    v_and_b32 v3, 0xffff0000, v39
    v_add_f32 v78, v78, v2
    v_add_f32 v79, v79, v3
    s_waitcnt vmcnt(3)
    v_lshlrev_b32 v2, 16, v40
    v_and_b32 v3, 0xffff0000, v40
    v_add_f32 v64, v64, v2
    v_add_f32 v65, v65, v3
    v_lshlrev_b32 v2, 16, v41
    v_and_b32 v3, 0xffff0000, v41
    v_add_f32 v66, v66, v2
    v_add_f32 v67, v67, v3
    v_lshlrev_b32 v2, 16, v42
    v_and_b32 v3, 0xffff0000, v42
    v_add_f32 v68, v68, v2
    v_add_f32 v69, v69, v3
    v_lshlrev_b32 v2, 16, v43
    v_and_b32 v3, 0xffff0000, v43
    v_add_f32 v70, v70, v2
    v_add_f32 v71, v71, v3
    s_waitcnt vmcnt(2)
    v_lshlrev_b32 v2, 16, v44
    v_and_b32 v3, 0xffff0000, v44
    v_add_f32 v72, v72, v2
    v_add_f32 v73, v73, v3
    v_lshlrev_b32 v2, 16, v45
    v_and_b32 v3, 0xffff0000, v45
    v_add_f32 v74, v74, v2
    v_add_f32 v75, v75, v3
    v_lshlrev_b32 v2, 16, v46
    v_and_b32 v3, 0xffff0000, v46
    v_add_f32 v76, v76, v2
    v_add_f32 v77, v77, v3
    v_lshlrev_b32 v2, 16, v47
    v_and_b32 v3, 0xffff0000, v47
    v_add_f32 v78, v78, v2
    v_add_f32 v79, v79, v3
    s_waitcnt vmcnt(1)
    v_lshlrev_b32 v2, 16, v48
    v_and_b32 v3, 0xffff0000, v48
    v_add_f32 v64, v64, v2
    v_add_f32 v65, v65, v3
    v_lshlrev_b32 v2, 16, v49
    v_and_b32 v3, 0xffff0000, v49
    v_add_f32 v66, v66, v2
    v_add_f32 v67, v67, v3
    v_lshlrev_b32 v2, 16, v50
    v_and_b32 v3, 0xffff0000, v50
    v_add_f32 v68, v68, v2
    v_add_f32 v69, v69, v3
    v_lshlrev_b32 v2, 16, v51
    v_and_b32 v3, 0xffff0000, v51
    v_add_f32 v70, v70, v2
    v_add_f32 v71, v71, v3
    s_waitcnt vmcnt(0)
    v_lshlrev_b32 v2, 16, v52
    v_and_b32 v3, 0xffff0000, v52
    v_add_f32 v72, v72, v2
    v_add_f32 v73, v73, v3
    v_lshlrev_b32 v2, 16, v53
    v_and_b32 v3, 0xffff0000, v53
    v_add_f32 v74, v74, v2
    v_add_f32 v75, v75, v3
    v_lshlrev_b32 v2, 16, v54
    v_and_b32 v3, 0xffff0000, v54
    v_add_f32 v76, v76, v2
    v_add_f32 v77, v77, v3
    v_lshlrev_b32 v2, 16, v55
    v_and_b32 v3, 0xffff0000, v55
    v_add_f32 v78, v78, v2
    v_add_f32 v79, v79, v3
    v_cvt_pk_bf16_f32 v80, v64, v65
    v_cvt_pk_bf16_f32 v81, v66, v67
    v_cvt_pk_bf16_f32 v82, v68, v69
    v_cvt_pk_bf16_f32 v83, v70, v71
    v_cvt_pk_bf16_f32 v84, v72, v73
    v_cvt_pk_bf16_f32 v85, v74, v75
    v_cvt_pk_bf16_f32 v86, v76, v77
    v_cvt_pk_bf16_f32 v87, v78, v79
    buffer_store_dwordx4 v[80:83], v4, s[32:35], s48 offen offset:0
    buffer_store_dwordx4 v[84:87], v4, s[32:35], s48 offen offset:32
    s_branch L_fin
L_A:
    s_waitcnt lgkmcnt(0)
    s_lshr_b32 s41, s2, 5
    s_and_b32 s86, s2, 7
    s_lshl_b32 s86, s86, 3
    s_add_u32 s86, s86, s41
    s_lshl_b32 s86, s86, 8
    s_add_u32 s86, s86, 0x3000000
    s_lshl_b32 s84, s36, 4
    s_add_u32 s84, s84, s86
    s_add_u32 s84, s84, 128
    s_lshl_b32 s99, s37, 2
    s_add_u32 s99, s99, s87
    s_lshl_b32 s99, s99, 8
    s_add_u32 s99, s99, 0x3008000
    s_lshl_b32 s41, s37, 2
    s_add_u32 s41, s41, s36
    s_lshl_b32 s75, s41, 18
    s_mov_b32 s8, s54
    s_and_b32 s9, s55, 0xffff
    s_mov_b32 s10, 0x4000000
    s_mov_b32 s11, 0x20000
    s_mov_b32 s12, s56
    s_and_b32 s13, s57, 0xffff
    s_mov_b32 s14, 0x4000000
    s_mov_b32 s15, 0x20000
    s_mov_b32 s28, s60
    s_and_b32 s29, s61, 0xffff
    s_mov_b32 s30, 0x400000
    s_mov_b32 s31, 0x20000
    s_mov_b32 s32, s62
    s_and_b32 s33, s63, 0xffff
    s_mov_b32 s34, 0x200000
    s_mov_b32 s35, 0x20000
    s_mov_b32 s24, s66
    s_and_b32 s25, s67, 0xffff
    s_mov_b32 s26, 0x10000000
    s_mov_b32 s27, 0x20000
    s_mov_b32 s88, s64
    s_and_b32 s89, s65, 0xffff
    s_mov_b32 s90, 0x100
    s_mov_b32 s91, 0x20000
    s_getpc_b64 s[96:97]
L_pc:
    s_sub_u32 s96, s96, L_pc-standalone__mha_block_cached__near_ridge_kernel
    s_subb_u32 s97, s97, 0
    s_lshr_b32 s41, s2, 3
    s_lshl_b32 s41, s41, 2
    s_add_u32 s41, s41, s36
    s_and_b32 s41, s41, 63
    s_lshl_b32 s41, s41, 10
    s_mov_b32 s80, s96
    s_and_b32 s81, s97, 0xffff
    s_mov_b32 s82, L_end-standalone__mha_block_cached__near_ridge_kernel
    s_mov_b32 s83, 0x20000
    v_lshlrev_b32 v7, 4, v1
    buffer_load_dwordx4 v[60:63], v7, s[80:83], s41 offen
    v_lshlrev_b32 v7, 4, v1
    v_mov_b32 v6, 0
    s_mov_b32 s44, 0x3e0293ee
    v_bfe_u32 v2, v1, 2, 2
    v_lshrrev_b32 v3, 5, v1
    v_mad_u32_u24 v3, v3, 8, v2
    v_lshlrev_b32 v3, 8, v3
    v_and_b32 v4, 16, v1
    v_lshl_add_u32 v3, v4, 1, v3
    v_and_b32 v4, 1, v1
    v_lshl_add_u32 v3, v4, 4, v3
    v_and_b32 v4, 2, v1
    v_lshl_add_u32 v3, v4, 2, v3
    v_xor_b32 v4, 0, v2
    v_lshl_add_u32 v28, v4, 6, v3
    v_xor_b32 v4, 1, v2
    v_lshl_add_u32 v29, v4, 6, v3
    v_xor_b32 v4, 2, v2
    v_lshl_add_u32 v30, v4, 6, v3
    v_xor_b32 v4, 3, v2
    v_lshl_add_u32 v31, v4, 6, v3
    v_bfe_u32 v2, v1, 1, 3
    v_lshrrev_b32 v3, 5, v1
    v_xor_b32 v2, v2, v3
    v_and_b32 v3, 31, v1
    v_lshlrev_b32 v3, 7, v3
    v_add_u32 v3, s50, v3
    v_xor_b32 v4, 0, v2
    v_lshl_add_u32 v8, v4, 4, v3
    v_xor_b32 v4, 2, v2
    v_lshl_add_u32 v9, v4, 4, v3
    v_xor_b32 v4, 4, v2
    v_lshl_add_u32 v10, v4, 4, v3
    v_xor_b32 v4, 6, v2
    v_lshl_add_u32 v11, v4, 4, v3
    s_lshl_b32 s41, s36, 13
    s_add_u32 s41, s41, 0x18000
    v_add_u32 v14, s41, v7
    s_xor_b32 s41, s38, 1
    s_lshl_b32 s41, s41, 13
    s_add_u32 s49, s75, s41
    v_bfe_u32 v2, v1, 2, 2
    v_lshrrev_b32 v3, 5, v1
    v_mad_u32_u24 v3, v3, 4, v2
    v_lshlrev_b32 v3, 8, v3
    v_and_b32 v4, 16, v1
    v_lshl_add_u32 v3, v4, 1, v3
    v_and_b32 v4, 1, v1
    v_lshl_add_u32 v3, v4, 4, v3
    v_and_b32 v4, 2, v1
    v_lshl_add_u32 v3, v4, 2, v3
    v_add_u32 v3, 0xc000, v3
    v_xor_b32 v4, 0, v2
    v_lshl_add_u32 v24, v4, 6, v3
    v_xor_b32 v4, 1, v2
    v_lshl_add_u32 v25, v4, 6, v3
    v_xor_b32 v4, 2, v2
    v_lshl_add_u32 v26, v4, 6, v3
    v_xor_b32 v4, 3, v2
    v_lshl_add_u32 v27, v4, 6, v3
    v_and_b32 v2, 15, v1
    v_lshrrev_b32 v3, 5, v1
    v_xor_b32 v2, v2, v3
    v_and_b32 v3, 31, v1
    v_lshlrev_b32 v3, 8, v3
    v_xor_b32 v4, 0, v2
    v_lshl_add_u32 v16, v4, 4, v3
    v_xor_b32 v4, 2, v2
    v_lshl_add_u32 v17, v4, 4, v3
    v_xor_b32 v4, 4, v2
    v_lshl_add_u32 v18, v4, 4, v3
    v_xor_b32 v4, 6, v2
    v_lshl_add_u32 v19, v4, 4, v3
    v_xor_b32 v4, 8, v2
    v_lshl_add_u32 v20, v4, 4, v3
    v_xor_b32 v4, 10, v2
    v_lshl_add_u32 v21, v4, 4, v3
    v_xor_b32 v4, 12, v2
    v_lshl_add_u32 v22, v4, 4, v3
    v_xor_b32 v4, 14, v2
    v_lshl_add_u32 v23, v4, 4, v3
    s_or_b32 s41, s85, s87
    s_or_b32 s41, s41, s74
    s_cbranch_scc1 L_np
    s_memrealtime s[96:97]
    s_waitcnt lgkmcnt(0)
    s_or_b32 s98, s96, 1
    v_mov_b32 v12, s98
    s_lshl_b32 s41, s37, 2
    s_mov_b64 exec, 1
    buffer_store_dword v12, v6, s[88:91], s41 offen sc1
    s_mov_b64 exec, -1
    s_nop 0
L_np:
    s_cmp_eq_u32 s74, 0
    s_cselect_b32 s39, 5, 63
    v_add_u32 v8, 0x20000, v8
    v_add_u32 v9, 0x20000, v9
    v_add_u32 v10, 0x20000, v10
    v_add_u32 v11, 0x20000, v11
    v_add_u32 v28, 0x24000, v28
    v_add_u32 v29, 0x24000, v29
    v_add_u32 v30, 0x24000, v30
    v_add_u32 v31, 0x24000, v31
    s_barrier
    ds_read_b128 v[128:131], v8
    ds_read_b128 v[132:135], v9
    ds_read_b128 v[136:139], v10
    ds_read_b128 v[140:143], v11
    ds_read_b64_tr_b16 v[32:33], v28 offset:0
    ds_read_b64_tr_b16 v[34:35], v28 offset:1024
    ds_read_b64_tr_b16 v[36:37], v29 offset:0
    ds_read_b64_tr_b16 v[38:39], v29 offset:1024
    ds_read_b64_tr_b16 v[40:41], v30 offset:0
    ds_read_b64_tr_b16 v[42:43], v30 offset:1024
    ds_read_b64_tr_b16 v[44:45], v31 offset:0
    ds_read_b64_tr_b16 v[46:47], v31 offset:1024
    ds_read_b64_tr_b16 v[48:49], v28 offset:4096
    ds_read_b64_tr_b16 v[50:51], v28 offset:5120
    s_waitcnt lgkmcnt(8)
    v_mfma_f32_32x32x16_bf16 v[64:79], v[32:35], v[128:131], 0
    ds_read_b64_tr_b16 v[52:53], v29 offset:4096
    ds_read_b64_tr_b16 v[54:55], v29 offset:5120
    s_waitcnt lgkmcnt(8)
    v_mfma_f32_32x32x16_bf16 v[80:95], v[36:39], v[128:131], 0
    ds_read_b64_tr_b16 v[56:57], v30 offset:4096
    ds_read_b64_tr_b16 v[58:59], v30 offset:5120
    s_waitcnt lgkmcnt(8)
    v_mfma_f32_32x32x16_bf16 v[96:111], v[40:43], v[128:131], 0
    s_waitcnt vmcnt(0)
    ds_read_b64_tr_b16 v[60:61], v31 offset:4096
    ds_read_b64_tr_b16 v[62:63], v31 offset:5120
    s_waitcnt lgkmcnt(8)
    v_mfma_f32_32x32x16_bf16 v[112:127], v[44:47], v[128:131], 0
    ds_read_b64_tr_b16 v[32:33], v28 offset:8192
    ds_read_b64_tr_b16 v[34:35], v28 offset:9216
    s_waitcnt lgkmcnt(8)
    v_mfma_f32_32x32x16_bf16 v[64:79], v[48:51], v[132:135], v[64:79]
    ds_read_b64_tr_b16 v[36:37], v29 offset:8192
    ds_read_b64_tr_b16 v[38:39], v29 offset:9216
    s_waitcnt lgkmcnt(8)
    v_mfma_f32_32x32x16_bf16 v[80:95], v[52:55], v[132:135], v[80:95]
    ds_read_b64_tr_b16 v[40:41], v30 offset:8192
    ds_read_b64_tr_b16 v[42:43], v30 offset:9216
    s_waitcnt lgkmcnt(8)
    v_mfma_f32_32x32x16_bf16 v[96:111], v[56:59], v[132:135], v[96:111]
    ds_read_b64_tr_b16 v[44:45], v31 offset:8192
    ds_read_b64_tr_b16 v[46:47], v31 offset:9216
    s_waitcnt lgkmcnt(8)
    v_mfma_f32_32x32x16_bf16 v[112:127], v[60:63], v[132:135], v[112:127]
    ds_read_b64_tr_b16 v[48:49], v28 offset:12288
    ds_read_b64_tr_b16 v[50:51], v28 offset:13312
    s_waitcnt lgkmcnt(8)
    v_mfma_f32_32x32x16_bf16 v[64:79], v[32:35], v[136:139], v[64:79]
    ds_read_b64_tr_b16 v[52:53], v29 offset:12288
    ds_read_b64_tr_b16 v[54:55], v29 offset:13312
    s_waitcnt lgkmcnt(8)
    v_mfma_f32_32x32x16_bf16 v[80:95], v[36:39], v[136:139], v[80:95]
    ds_read_b64_tr_b16 v[56:57], v30 offset:12288
    ds_read_b64_tr_b16 v[58:59], v30 offset:13312
    s_waitcnt lgkmcnt(8)
    v_mfma_f32_32x32x16_bf16 v[96:111], v[40:43], v[136:139], v[96:111]
    ds_read_b64_tr_b16 v[60:61], v31 offset:12288
    ds_read_b64_tr_b16 v[62:63], v31 offset:13312
    s_waitcnt lgkmcnt(8)
    v_mfma_f32_32x32x16_bf16 v[112:127], v[44:47], v[136:139], v[112:127]
    v_add_u32 v8, 0xfffec000, v8
    v_add_u32 v9, 0xfffec000, v9
    v_add_u32 v10, 0xfffec000, v10
    v_add_u32 v11, 0xfffec000, v11
    v_add_u32 v28, 0xfffec000, v28
    v_add_u32 v29, 0xfffec000, v29
    v_add_u32 v30, 0xfffec000, v30
    v_add_u32 v31, 0xfffec000, v31
    s_barrier
    ds_read_b128 v[144:147], v8
    ds_read_b128 v[148:151], v9
    ds_read_b128 v[152:155], v10
    ds_read_b128 v[156:159], v11
    ds_read_b64_tr_b16 v[32:33], v28 offset:0
    ds_read_b64_tr_b16 v[34:35], v28 offset:1024
    s_waitcnt lgkmcnt(12)
    v_mfma_f32_32x32x16_bf16 v[64:79], v[48:51], v[140:143], v[64:79]
    ds_read_b64_tr_b16 v[36:37], v29 offset:0
    ds_read_b64_tr_b16 v[38:39], v29 offset:1024
    s_waitcnt lgkmcnt(12)
    v_mfma_f32_32x32x16_bf16 v[80:95], v[52:55], v[140:143], v[80:95]
    ds_read_b64_tr_b16 v[40:41], v30 offset:0
    ds_read_b64_tr_b16 v[42:43], v30 offset:1024
    s_waitcnt lgkmcnt(12)
    v_mfma_f32_32x32x16_bf16 v[96:111], v[56:59], v[140:143], v[96:111]
    ds_read_b64_tr_b16 v[44:45], v31 offset:0
    ds_read_b64_tr_b16 v[46:47], v31 offset:1024
    s_waitcnt lgkmcnt(12)
    v_mfma_f32_32x32x16_bf16 v[112:127], v[60:63], v[140:143], v[112:127]
    ds_read_b64_tr_b16 v[48:49], v28 offset:4096
    ds_read_b64_tr_b16 v[50:51], v28 offset:5120
    s_waitcnt lgkmcnt(8)
    v_mfma_f32_32x32x16_bf16 v[64:79], v[32:35], v[144:147], v[64:79]
    ds_read_b64_tr_b16 v[52:53], v29 offset:4096
    ds_read_b64_tr_b16 v[54:55], v29 offset:5120
    s_waitcnt lgkmcnt(8)
    v_mfma_f32_32x32x16_bf16 v[80:95], v[36:39], v[144:147], v[80:95]
    ds_read_b64_tr_b16 v[56:57], v30 offset:4096
    ds_read_b64_tr_b16 v[58:59], v30 offset:5120
    s_waitcnt lgkmcnt(8)
    v_mfma_f32_32x32x16_bf16 v[96:111], v[40:43], v[144:147], v[96:111]
    ds_read_b64_tr_b16 v[60:61], v31 offset:4096
    ds_read_b64_tr_b16 v[62:63], v31 offset:5120
    s_waitcnt lgkmcnt(8)
    v_mfma_f32_32x32x16_bf16 v[112:127], v[44:47], v[144:147], v[112:127]
    ds_read_b64_tr_b16 v[32:33], v28 offset:8192
    ds_read_b64_tr_b16 v[34:35], v28 offset:9216
    s_waitcnt lgkmcnt(8)
    v_mfma_f32_32x32x16_bf16 v[64:79], v[48:51], v[148:151], v[64:79]
    ds_read_b64_tr_b16 v[36:37], v29 offset:8192
    ds_read_b64_tr_b16 v[38:39], v29 offset:9216
    s_waitcnt lgkmcnt(8)
    v_mfma_f32_32x32x16_bf16 v[80:95], v[52:55], v[148:151], v[80:95]
    ds_read_b64_tr_b16 v[40:41], v30 offset:8192
    ds_read_b64_tr_b16 v[42:43], v30 offset:9216
    s_waitcnt lgkmcnt(8)
    v_mfma_f32_32x32x16_bf16 v[96:111], v[56:59], v[148:151], v[96:111]
    ds_read_b64_tr_b16 v[44:45], v31 offset:8192
    ds_read_b64_tr_b16 v[46:47], v31 offset:9216
    s_waitcnt lgkmcnt(8)
    v_mfma_f32_32x32x16_bf16 v[112:127], v[60:63], v[148:151], v[112:127]
    ds_read_b64_tr_b16 v[48:49], v28 offset:12288
    ds_read_b64_tr_b16 v[50:51], v28 offset:13312
    s_waitcnt lgkmcnt(8)
    v_mfma_f32_32x32x16_bf16 v[64:79], v[32:35], v[152:155], v[64:79]
    ds_read_b64_tr_b16 v[52:53], v29 offset:12288
    ds_read_b64_tr_b16 v[54:55], v29 offset:13312
    s_waitcnt lgkmcnt(8)
    v_mfma_f32_32x32x16_bf16 v[80:95], v[36:39], v[152:155], v[80:95]
    ds_read_b64_tr_b16 v[56:57], v30 offset:12288
    ds_read_b64_tr_b16 v[58:59], v30 offset:13312
    s_waitcnt lgkmcnt(8)
    v_mfma_f32_32x32x16_bf16 v[96:111], v[40:43], v[152:155], v[96:111]
    ds_read_b64_tr_b16 v[60:61], v31 offset:12288
    ds_read_b64_tr_b16 v[62:63], v31 offset:13312
    s_waitcnt lgkmcnt(8)
    v_mfma_f32_32x32x16_bf16 v[112:127], v[44:47], v[152:155], v[112:127]
    v_add_u32 v8, 0x8000, v8
    v_add_u32 v9, 0x8000, v9
    v_add_u32 v10, 0x8000, v10
    v_add_u32 v11, 0x8000, v11
    v_add_u32 v28, 0xffff8000, v28
    v_add_u32 v29, 0xffff8000, v29
    v_add_u32 v30, 0xffff8000, v30
    v_add_u32 v31, 0xffff8000, v31
    s_barrier
    ds_read_b128 v[160:163], v8
    ds_read_b128 v[164:167], v9
    ds_read_b128 v[168:171], v10
    ds_read_b128 v[172:175], v11
    ds_read_b64_tr_b16 v[32:33], v28 offset:0
    ds_read_b64_tr_b16 v[34:35], v28 offset:1024
    s_waitcnt lgkmcnt(12)
    v_mfma_f32_32x32x16_bf16 v[64:79], v[48:51], v[156:159], v[64:79]
    ds_read_b64_tr_b16 v[36:37], v29 offset:0
    ds_read_b64_tr_b16 v[38:39], v29 offset:1024
    s_waitcnt lgkmcnt(12)
    v_mfma_f32_32x32x16_bf16 v[80:95], v[52:55], v[156:159], v[80:95]
    ds_read_b64_tr_b16 v[40:41], v30 offset:0
    ds_read_b64_tr_b16 v[42:43], v30 offset:1024
    s_waitcnt lgkmcnt(12)
    v_mfma_f32_32x32x16_bf16 v[96:111], v[56:59], v[156:159], v[96:111]
    ds_read_b64_tr_b16 v[44:45], v31 offset:0
    ds_read_b64_tr_b16 v[46:47], v31 offset:1024
    s_waitcnt lgkmcnt(12)
    v_mfma_f32_32x32x16_bf16 v[112:127], v[60:63], v[156:159], v[112:127]
    ds_read_b64_tr_b16 v[48:49], v28 offset:4096
    ds_read_b64_tr_b16 v[50:51], v28 offset:5120
    s_waitcnt lgkmcnt(8)
    v_mfma_f32_32x32x16_bf16 v[64:79], v[32:35], v[160:163], v[64:79]
    ds_read_b64_tr_b16 v[52:53], v29 offset:4096
    ds_read_b64_tr_b16 v[54:55], v29 offset:5120
    s_waitcnt lgkmcnt(8)
    v_mfma_f32_32x32x16_bf16 v[80:95], v[36:39], v[160:163], v[80:95]
    ds_read_b64_tr_b16 v[56:57], v30 offset:4096
    ds_read_b64_tr_b16 v[58:59], v30 offset:5120
    s_waitcnt lgkmcnt(8)
    v_mfma_f32_32x32x16_bf16 v[96:111], v[40:43], v[160:163], v[96:111]
    ds_read_b64_tr_b16 v[60:61], v31 offset:4096
    ds_read_b64_tr_b16 v[62:63], v31 offset:5120
    s_waitcnt lgkmcnt(8)
    v_mfma_f32_32x32x16_bf16 v[112:127], v[44:47], v[160:163], v[112:127]
    ds_read_b64_tr_b16 v[32:33], v28 offset:8192
    ds_read_b64_tr_b16 v[34:35], v28 offset:9216
    s_waitcnt lgkmcnt(8)
    v_mfma_f32_32x32x16_bf16 v[64:79], v[48:51], v[164:167], v[64:79]
    ds_read_b64_tr_b16 v[36:37], v29 offset:8192
    ds_read_b64_tr_b16 v[38:39], v29 offset:9216
    s_waitcnt lgkmcnt(8)
    v_mfma_f32_32x32x16_bf16 v[80:95], v[52:55], v[164:167], v[80:95]
    ds_read_b64_tr_b16 v[40:41], v30 offset:8192
    ds_read_b64_tr_b16 v[42:43], v30 offset:9216
    s_waitcnt lgkmcnt(8)
    v_mfma_f32_32x32x16_bf16 v[96:111], v[56:59], v[164:167], v[96:111]
    ds_read_b64_tr_b16 v[44:45], v31 offset:8192
    ds_read_b64_tr_b16 v[46:47], v31 offset:9216
    s_waitcnt lgkmcnt(8)
    v_mfma_f32_32x32x16_bf16 v[112:127], v[60:63], v[164:167], v[112:127]
    ds_read_b64_tr_b16 v[48:49], v28 offset:12288
    ds_read_b64_tr_b16 v[50:51], v28 offset:13312
    s_waitcnt lgkmcnt(8)
    v_mfma_f32_32x32x16_bf16 v[64:79], v[32:35], v[168:171], v[64:79]
    ds_read_b64_tr_b16 v[52:53], v29 offset:12288
    ds_read_b64_tr_b16 v[54:55], v29 offset:13312
    s_waitcnt lgkmcnt(8)
    v_mfma_f32_32x32x16_bf16 v[80:95], v[36:39], v[168:171], v[80:95]
    ds_read_b64_tr_b16 v[56:57], v30 offset:12288
    ds_read_b64_tr_b16 v[58:59], v30 offset:13312
    s_waitcnt lgkmcnt(8)
    v_mfma_f32_32x32x16_bf16 v[96:111], v[40:43], v[168:171], v[96:111]
    ds_read_b64_tr_b16 v[60:61], v31 offset:12288
    ds_read_b64_tr_b16 v[62:63], v31 offset:13312
    s_waitcnt lgkmcnt(8)
    v_mfma_f32_32x32x16_bf16 v[112:127], v[44:47], v[168:171], v[112:127]
    v_add_u32 v8, 0x4000, v8
    v_add_u32 v9, 0x4000, v9
    v_add_u32 v10, 0x4000, v10
    v_add_u32 v11, 0x4000, v11
    v_add_u32 v28, 0x14000, v28
    v_add_u32 v29, 0x14000, v29
    v_add_u32 v30, 0x14000, v30
    v_add_u32 v31, 0x14000, v31
    s_barrier
    ds_read_b128 v[176:179], v8
    ds_read_b128 v[180:183], v9
    ds_read_b128 v[184:187], v10
    ds_read_b128 v[188:191], v11
    ds_read_b64_tr_b16 v[32:33], v28 offset:0
    ds_read_b64_tr_b16 v[34:35], v28 offset:1024
    s_waitcnt lgkmcnt(12)
    v_mfma_f32_32x32x16_bf16 v[64:79], v[48:51], v[172:175], v[64:79]
    ds_read_b64_tr_b16 v[36:37], v29 offset:0
    ds_read_b64_tr_b16 v[38:39], v29 offset:1024
    s_waitcnt lgkmcnt(12)
    v_mfma_f32_32x32x16_bf16 v[80:95], v[52:55], v[172:175], v[80:95]
    ds_read_b64_tr_b16 v[40:41], v30 offset:0
    ds_read_b64_tr_b16 v[42:43], v30 offset:1024
    s_waitcnt lgkmcnt(12)
    v_mfma_f32_32x32x16_bf16 v[96:111], v[56:59], v[172:175], v[96:111]
    ds_read_b64_tr_b16 v[44:45], v31 offset:0
    ds_read_b64_tr_b16 v[46:47], v31 offset:1024
    s_waitcnt lgkmcnt(12)
    v_mfma_f32_32x32x16_bf16 v[112:127], v[60:63], v[172:175], v[112:127]
    ds_read_b64_tr_b16 v[48:49], v28 offset:4096
    ds_read_b64_tr_b16 v[50:51], v28 offset:5120
    s_waitcnt lgkmcnt(8)
    v_mfma_f32_32x32x16_bf16 v[64:79], v[32:35], v[176:179], v[64:79]
    ds_read_b64_tr_b16 v[52:53], v29 offset:4096
    ds_read_b64_tr_b16 v[54:55], v29 offset:5120
    s_waitcnt lgkmcnt(8)
    v_mfma_f32_32x32x16_bf16 v[80:95], v[36:39], v[176:179], v[80:95]
    ds_read_b64_tr_b16 v[56:57], v30 offset:4096
    ds_read_b64_tr_b16 v[58:59], v30 offset:5120
    s_waitcnt lgkmcnt(8)
    v_mfma_f32_32x32x16_bf16 v[96:111], v[40:43], v[176:179], v[96:111]
    ds_read_b64_tr_b16 v[60:61], v31 offset:4096
    ds_read_b64_tr_b16 v[62:63], v31 offset:5120
    s_waitcnt lgkmcnt(8)
    v_mfma_f32_32x32x16_bf16 v[112:127], v[44:47], v[176:179], v[112:127]
    ds_read_b64_tr_b16 v[32:33], v28 offset:8192
    ds_read_b64_tr_b16 v[34:35], v28 offset:9216
    s_waitcnt lgkmcnt(8)
    v_mfma_f32_32x32x16_bf16 v[64:79], v[48:51], v[180:183], v[64:79]
    ds_read_b64_tr_b16 v[36:37], v29 offset:8192
    ds_read_b64_tr_b16 v[38:39], v29 offset:9216
    s_waitcnt lgkmcnt(8)
    v_mfma_f32_32x32x16_bf16 v[80:95], v[52:55], v[180:183], v[80:95]
    ds_read_b64_tr_b16 v[40:41], v30 offset:8192
    ds_read_b64_tr_b16 v[42:43], v30 offset:9216
    s_waitcnt lgkmcnt(8)
    v_mfma_f32_32x32x16_bf16 v[96:111], v[56:59], v[180:183], v[96:111]
    ds_read_b64_tr_b16 v[44:45], v31 offset:8192
    ds_read_b64_tr_b16 v[46:47], v31 offset:9216
    s_waitcnt lgkmcnt(8)
    v_mfma_f32_32x32x16_bf16 v[112:127], v[60:63], v[180:183], v[112:127]
    ds_read_b64_tr_b16 v[48:49], v28 offset:12288
    ds_read_b64_tr_b16 v[50:51], v28 offset:13312
    s_waitcnt lgkmcnt(8)
    v_mfma_f32_32x32x16_bf16 v[64:79], v[32:35], v[184:187], v[64:79]
    ds_read_b64_tr_b16 v[52:53], v29 offset:12288
    ds_read_b64_tr_b16 v[54:55], v29 offset:13312
    s_waitcnt lgkmcnt(8)
    v_mfma_f32_32x32x16_bf16 v[80:95], v[36:39], v[184:187], v[80:95]
    ds_read_b64_tr_b16 v[56:57], v30 offset:12288
    ds_read_b64_tr_b16 v[58:59], v30 offset:13312
    s_waitcnt lgkmcnt(8)
    v_mfma_f32_32x32x16_bf16 v[96:111], v[40:43], v[184:187], v[96:111]
    ds_read_b64_tr_b16 v[60:61], v31 offset:12288
    ds_read_b64_tr_b16 v[62:63], v31 offset:13312
    s_waitcnt lgkmcnt(8)
    v_mfma_f32_32x32x16_bf16 v[112:127], v[44:47], v[184:187], v[112:127]
    v_add_u32 v8, 0x8000, v8
    v_add_u32 v9, 0x8000, v9
    v_add_u32 v10, 0x8000, v10
    v_add_u32 v11, 0x8000, v11
    v_add_u32 v28, 0x8000, v28
    v_add_u32 v29, 0x8000, v29
    v_add_u32 v30, 0x8000, v30
    v_add_u32 v31, 0x8000, v31
    s_barrier
    ds_read_b128 v[192:195], v8
    ds_read_b128 v[196:199], v9
    ds_read_b128 v[200:203], v10
    ds_read_b128 v[204:207], v11
    ds_read_b64_tr_b16 v[32:33], v28 offset:0
    ds_read_b64_tr_b16 v[34:35], v28 offset:1024
    s_waitcnt lgkmcnt(12)
    v_mfma_f32_32x32x16_bf16 v[64:79], v[48:51], v[188:191], v[64:79]
    ds_read_b64_tr_b16 v[36:37], v29 offset:0
    ds_read_b64_tr_b16 v[38:39], v29 offset:1024
    s_waitcnt lgkmcnt(12)
    v_mfma_f32_32x32x16_bf16 v[80:95], v[52:55], v[188:191], v[80:95]
    ds_read_b64_tr_b16 v[40:41], v30 offset:0
    ds_read_b64_tr_b16 v[42:43], v30 offset:1024
    s_waitcnt lgkmcnt(12)
    v_mfma_f32_32x32x16_bf16 v[96:111], v[56:59], v[188:191], v[96:111]
    ds_read_b64_tr_b16 v[44:45], v31 offset:0
    ds_read_b64_tr_b16 v[46:47], v31 offset:1024
    s_waitcnt lgkmcnt(12)
    v_mfma_f32_32x32x16_bf16 v[112:127], v[60:63], v[188:191], v[112:127]
    ds_read_b64_tr_b16 v[48:49], v28 offset:4096
    ds_read_b64_tr_b16 v[50:51], v28 offset:5120
    s_waitcnt lgkmcnt(8)
    v_mfma_f32_32x32x16_bf16 v[64:79], v[32:35], v[192:195], v[64:79]
    ds_read_b64_tr_b16 v[52:53], v29 offset:4096
    ds_read_b64_tr_b16 v[54:55], v29 offset:5120
    s_waitcnt lgkmcnt(8)
    v_mfma_f32_32x32x16_bf16 v[80:95], v[36:39], v[192:195], v[80:95]
    ds_read_b64_tr_b16 v[56:57], v30 offset:4096
    ds_read_b64_tr_b16 v[58:59], v30 offset:5120
    s_waitcnt lgkmcnt(8)
    v_mfma_f32_32x32x16_bf16 v[96:111], v[40:43], v[192:195], v[96:111]
    ds_read_b64_tr_b16 v[60:61], v31 offset:4096
    ds_read_b64_tr_b16 v[62:63], v31 offset:5120
    s_waitcnt lgkmcnt(8)
    v_mfma_f32_32x32x16_bf16 v[112:127], v[44:47], v[192:195], v[112:127]
    ds_read_b64_tr_b16 v[32:33], v28 offset:8192
    ds_read_b64_tr_b16 v[34:35], v28 offset:9216
    s_waitcnt lgkmcnt(8)
    v_mfma_f32_32x32x16_bf16 v[64:79], v[48:51], v[196:199], v[64:79]
    ds_read_b64_tr_b16 v[36:37], v29 offset:8192
    ds_read_b64_tr_b16 v[38:39], v29 offset:9216
    s_waitcnt lgkmcnt(8)
    v_mfma_f32_32x32x16_bf16 v[80:95], v[52:55], v[196:199], v[80:95]
    ds_read_b64_tr_b16 v[40:41], v30 offset:8192
    ds_read_b64_tr_b16 v[42:43], v30 offset:9216
    s_waitcnt lgkmcnt(8)
    v_mfma_f32_32x32x16_bf16 v[96:111], v[56:59], v[196:199], v[96:111]
    ds_read_b64_tr_b16 v[44:45], v31 offset:8192
    ds_read_b64_tr_b16 v[46:47], v31 offset:9216
    s_waitcnt lgkmcnt(8)
    v_mfma_f32_32x32x16_bf16 v[112:127], v[60:63], v[196:199], v[112:127]
    ds_read_b64_tr_b16 v[48:49], v28 offset:12288
    ds_read_b64_tr_b16 v[50:51], v28 offset:13312
    s_waitcnt lgkmcnt(8)
    v_mfma_f32_32x32x16_bf16 v[64:79], v[32:35], v[200:203], v[64:79]
    ds_read_b64_tr_b16 v[52:53], v29 offset:12288
    ds_read_b64_tr_b16 v[54:55], v29 offset:13312
    s_waitcnt lgkmcnt(8)
    v_mfma_f32_32x32x16_bf16 v[80:95], v[36:39], v[200:203], v[80:95]
    ds_read_b64_tr_b16 v[56:57], v30 offset:12288
    ds_read_b64_tr_b16 v[58:59], v30 offset:13312
    s_waitcnt lgkmcnt(8)
    v_mfma_f32_32x32x16_bf16 v[96:111], v[40:43], v[200:203], v[96:111]
    ds_read_b64_tr_b16 v[60:61], v31 offset:12288
    ds_read_b64_tr_b16 v[62:63], v31 offset:13312
    s_waitcnt lgkmcnt(8)
    v_mfma_f32_32x32x16_bf16 v[112:127], v[44:47], v[200:203], v[112:127]
    v_add_u32 v8, 0xfffec000, v8
    v_add_u32 v9, 0xfffec000, v9
    v_add_u32 v10, 0xfffec000, v10
    v_add_u32 v11, 0xfffec000, v11
    v_add_u32 v28, 0xfffec000, v28
    v_add_u32 v29, 0xfffec000, v29
    v_add_u32 v30, 0xfffec000, v30
    v_add_u32 v31, 0xfffec000, v31
    s_barrier
    ds_read_b128 v[208:211], v8
    ds_read_b128 v[212:215], v9
    ds_read_b128 v[216:219], v10
    ds_read_b128 v[220:223], v11
    ds_read_b64_tr_b16 v[32:33], v28 offset:0
    ds_read_b64_tr_b16 v[34:35], v28 offset:1024
    s_waitcnt lgkmcnt(12)
    v_mfma_f32_32x32x16_bf16 v[64:79], v[48:51], v[204:207], v[64:79]
    ds_read_b64_tr_b16 v[36:37], v29 offset:0
    ds_read_b64_tr_b16 v[38:39], v29 offset:1024
    s_waitcnt lgkmcnt(12)
    v_mfma_f32_32x32x16_bf16 v[80:95], v[52:55], v[204:207], v[80:95]
    ds_read_b64_tr_b16 v[40:41], v30 offset:0
    ds_read_b64_tr_b16 v[42:43], v30 offset:1024
    s_waitcnt lgkmcnt(12)
    v_mfma_f32_32x32x16_bf16 v[96:111], v[56:59], v[204:207], v[96:111]
    ds_read_b64_tr_b16 v[44:45], v31 offset:0
    ds_read_b64_tr_b16 v[46:47], v31 offset:1024
    s_waitcnt lgkmcnt(12)
    v_mfma_f32_32x32x16_bf16 v[112:127], v[60:63], v[204:207], v[112:127]
    ds_read_b64_tr_b16 v[48:49], v28 offset:4096
    ds_read_b64_tr_b16 v[50:51], v28 offset:5120
    s_waitcnt lgkmcnt(8)
    v_mfma_f32_32x32x16_bf16 v[64:79], v[32:35], v[208:211], v[64:79]
    ds_read_b64_tr_b16 v[52:53], v29 offset:4096
    ds_read_b64_tr_b16 v[54:55], v29 offset:5120
    s_waitcnt lgkmcnt(8)
    v_mfma_f32_32x32x16_bf16 v[80:95], v[36:39], v[208:211], v[80:95]
    ds_read_b64_tr_b16 v[56:57], v30 offset:4096
    ds_read_b64_tr_b16 v[58:59], v30 offset:5120
    s_waitcnt lgkmcnt(8)
    v_mfma_f32_32x32x16_bf16 v[96:111], v[40:43], v[208:211], v[96:111]
    ds_read_b64_tr_b16 v[60:61], v31 offset:4096
    ds_read_b64_tr_b16 v[62:63], v31 offset:5120
    s_waitcnt lgkmcnt(8)
    v_mfma_f32_32x32x16_bf16 v[112:127], v[44:47], v[208:211], v[112:127]
    ds_read_b64_tr_b16 v[32:33], v28 offset:8192
    ds_read_b64_tr_b16 v[34:35], v28 offset:9216
    s_waitcnt lgkmcnt(8)
    v_mfma_f32_32x32x16_bf16 v[64:79], v[48:51], v[212:215], v[64:79]
    ds_read_b64_tr_b16 v[36:37], v29 offset:8192
    ds_read_b64_tr_b16 v[38:39], v29 offset:9216
    s_waitcnt lgkmcnt(8)
    v_mfma_f32_32x32x16_bf16 v[80:95], v[52:55], v[212:215], v[80:95]
    ds_read_b64_tr_b16 v[40:41], v30 offset:8192
    ds_read_b64_tr_b16 v[42:43], v30 offset:9216
    s_waitcnt lgkmcnt(8)
    v_mfma_f32_32x32x16_bf16 v[96:111], v[56:59], v[212:215], v[96:111]
    ds_read_b64_tr_b16 v[44:45], v31 offset:8192
    ds_read_b64_tr_b16 v[46:47], v31 offset:9216
    s_waitcnt lgkmcnt(8)
    v_mfma_f32_32x32x16_bf16 v[112:127], v[60:63], v[212:215], v[112:127]
    ds_read_b64_tr_b16 v[48:49], v28 offset:12288
    ds_read_b64_tr_b16 v[50:51], v28 offset:13312
    s_waitcnt lgkmcnt(8)
    v_mfma_f32_32x32x16_bf16 v[64:79], v[32:35], v[216:219], v[64:79]
    ds_read_b64_tr_b16 v[52:53], v29 offset:12288
    ds_read_b64_tr_b16 v[54:55], v29 offset:13312
    s_waitcnt lgkmcnt(8)
    v_mfma_f32_32x32x16_bf16 v[80:95], v[36:39], v[216:219], v[80:95]
    ds_read_b64_tr_b16 v[56:57], v30 offset:12288
    ds_read_b64_tr_b16 v[58:59], v30 offset:13312
    s_waitcnt lgkmcnt(8)
    v_mfma_f32_32x32x16_bf16 v[96:111], v[40:43], v[216:219], v[96:111]
    ds_read_b64_tr_b16 v[60:61], v31 offset:12288
    ds_read_b64_tr_b16 v[62:63], v31 offset:13312
    s_waitcnt lgkmcnt(8)
    v_mfma_f32_32x32x16_bf16 v[112:127], v[44:47], v[216:219], v[112:127]
    v_add_u32 v8, 0x8000, v8
    v_add_u32 v9, 0x8000, v9
    v_add_u32 v10, 0x8000, v10
    v_add_u32 v11, 0x8000, v11
    v_add_u32 v28, 0xffff8000, v28
    v_add_u32 v29, 0xffff8000, v29
    v_add_u32 v30, 0xffff8000, v30
    v_add_u32 v31, 0xffff8000, v31
    s_barrier
    ds_read_b128 v[224:227], v8
    ds_read_b128 v[228:231], v9
    ds_read_b128 v[232:235], v10
    ds_read_b128 v[236:239], v11
    ds_read_b64_tr_b16 v[32:33], v28 offset:0
    ds_read_b64_tr_b16 v[34:35], v28 offset:1024
    s_waitcnt lgkmcnt(12)
    v_mfma_f32_32x32x16_bf16 v[64:79], v[48:51], v[220:223], v[64:79]
    ds_read_b64_tr_b16 v[36:37], v29 offset:0
    ds_read_b64_tr_b16 v[38:39], v29 offset:1024
    s_waitcnt lgkmcnt(12)
    v_mfma_f32_32x32x16_bf16 v[80:95], v[52:55], v[220:223], v[80:95]
    ds_read_b64_tr_b16 v[40:41], v30 offset:0
    ds_read_b64_tr_b16 v[42:43], v30 offset:1024
    s_waitcnt lgkmcnt(12)
    v_mfma_f32_32x32x16_bf16 v[96:111], v[56:59], v[220:223], v[96:111]
    ds_read_b64_tr_b16 v[44:45], v31 offset:0
    ds_read_b64_tr_b16 v[46:47], v31 offset:1024
    s_waitcnt lgkmcnt(12)
    v_mfma_f32_32x32x16_bf16 v[112:127], v[60:63], v[220:223], v[112:127]
    ds_read_b64_tr_b16 v[48:49], v28 offset:4096
    ds_read_b64_tr_b16 v[50:51], v28 offset:5120
    s_waitcnt lgkmcnt(8)
    v_mfma_f32_32x32x16_bf16 v[64:79], v[32:35], v[224:227], v[64:79]
    ds_read_b64_tr_b16 v[52:53], v29 offset:4096
    ds_read_b64_tr_b16 v[54:55], v29 offset:5120
    s_waitcnt lgkmcnt(8)
    v_mfma_f32_32x32x16_bf16 v[80:95], v[36:39], v[224:227], v[80:95]
    ds_read_b64_tr_b16 v[56:57], v30 offset:4096
    ds_read_b64_tr_b16 v[58:59], v30 offset:5120
    s_waitcnt lgkmcnt(8)
    v_mfma_f32_32x32x16_bf16 v[96:111], v[40:43], v[224:227], v[96:111]
    ds_read_b64_tr_b16 v[60:61], v31 offset:4096
    ds_read_b64_tr_b16 v[62:63], v31 offset:5120
    s_waitcnt lgkmcnt(8)
    v_mfma_f32_32x32x16_bf16 v[112:127], v[44:47], v[224:227], v[112:127]
    ds_read_b64_tr_b16 v[32:33], v28 offset:8192
    ds_read_b64_tr_b16 v[34:35], v28 offset:9216
    s_waitcnt lgkmcnt(8)
    v_mfma_f32_32x32x16_bf16 v[64:79], v[48:51], v[228:231], v[64:79]
    ds_read_b64_tr_b16 v[36:37], v29 offset:8192
    ds_read_b64_tr_b16 v[38:39], v29 offset:9216
    s_waitcnt lgkmcnt(8)
    v_mfma_f32_32x32x16_bf16 v[80:95], v[52:55], v[228:231], v[80:95]
    ds_read_b64_tr_b16 v[40:41], v30 offset:8192
    ds_read_b64_tr_b16 v[42:43], v30 offset:9216
    s_waitcnt lgkmcnt(8)
    v_mfma_f32_32x32x16_bf16 v[96:111], v[56:59], v[228:231], v[96:111]
    ds_read_b64_tr_b16 v[44:45], v31 offset:8192
    ds_read_b64_tr_b16 v[46:47], v31 offset:9216
    s_waitcnt lgkmcnt(8)
    v_mfma_f32_32x32x16_bf16 v[112:127], v[60:63], v[228:231], v[112:127]
    ds_read_b64_tr_b16 v[48:49], v28 offset:12288
    ds_read_b64_tr_b16 v[50:51], v28 offset:13312
    s_waitcnt lgkmcnt(8)
    v_mfma_f32_32x32x16_bf16 v[64:79], v[32:35], v[232:235], v[64:79]
    ds_read_b64_tr_b16 v[52:53], v29 offset:12288
    ds_read_b64_tr_b16 v[54:55], v29 offset:13312
    s_waitcnt lgkmcnt(8)
    v_mfma_f32_32x32x16_bf16 v[80:95], v[36:39], v[232:235], v[80:95]
    ds_read_b64_tr_b16 v[56:57], v30 offset:12288
    ds_read_b64_tr_b16 v[58:59], v30 offset:13312
    s_waitcnt lgkmcnt(8)
    v_mfma_f32_32x32x16_bf16 v[96:111], v[40:43], v[232:235], v[96:111]
    ds_read_b64_tr_b16 v[60:61], v31 offset:12288
    ds_read_b64_tr_b16 v[62:63], v31 offset:13312
    s_waitcnt lgkmcnt(8)
    v_mfma_f32_32x32x16_bf16 v[112:127], v[44:47], v[232:235], v[112:127]
    v_add_u32 v8, 0x4000, v8
    v_add_u32 v9, 0x4000, v9
    v_add_u32 v10, 0x4000, v10
    v_add_u32 v11, 0x4000, v11
    v_add_u32 v28, 0x14000, v28
    v_add_u32 v29, 0x14000, v29
    v_add_u32 v30, 0x14000, v30
    v_add_u32 v31, 0x14000, v31
    s_barrier
    ds_read_b128 v[240:243], v8
    ds_read_b128 v[244:247], v9
    ds_read_b128 v[248:251], v10
    ds_read_b128 v[252:255], v11
    ds_read_b64_tr_b16 v[32:33], v28 offset:0
    ds_read_b64_tr_b16 v[34:35], v28 offset:1024
    s_waitcnt lgkmcnt(12)
    v_mfma_f32_32x32x16_bf16 v[64:79], v[48:51], v[236:239], v[64:79]
    ds_read_b64_tr_b16 v[36:37], v28 offset:4096
    ds_read_b64_tr_b16 v[38:39], v28 offset:5120
    s_waitcnt lgkmcnt(12)
    v_mfma_f32_32x32x16_bf16 v[80:95], v[52:55], v[236:239], v[80:95]
    ds_read_b64_tr_b16 v[40:41], v28 offset:8192
    ds_read_b64_tr_b16 v[42:43], v28 offset:9216
    s_waitcnt lgkmcnt(12)
    v_mfma_f32_32x32x16_bf16 v[96:111], v[56:59], v[236:239], v[96:111]
    ds_read_b64_tr_b16 v[44:45], v28 offset:12288
    ds_read_b64_tr_b16 v[46:47], v28 offset:13312
    s_waitcnt lgkmcnt(12)
    v_mfma_f32_32x32x16_bf16 v[112:127], v[60:63], v[236:239], v[112:127]
    ds_read_b64_tr_b16 v[48:49], v29 offset:0
    ds_read_b64_tr_b16 v[50:51], v29 offset:1024
    s_waitcnt lgkmcnt(8)
    v_mfma_f32_32x32x16_bf16 v[64:79], v[32:35], v[240:243], v[64:79]
    ds_read_b64_tr_b16 v[52:53], v29 offset:4096
    ds_read_b64_tr_b16 v[54:55], v29 offset:5120
    v_mov_b32 v208, 0
    v_mov_b32 v209, 0
    v_mov_b32 v210, 0
    v_mov_b32 v211, 0
    s_waitcnt lgkmcnt(8)
    v_mfma_f32_32x32x16_bf16 v[64:79], v[36:39], v[244:247], v[64:79]
    ds_read_b64_tr_b16 v[56:57], v29 offset:8192
    ds_read_b64_tr_b16 v[58:59], v29 offset:9216
    v_mov_b32 v212, 0
    v_mov_b32 v213, 0
    v_mov_b32 v214, 0
    v_mov_b32 v215, 0
    s_waitcnt lgkmcnt(8)
    v_mfma_f32_32x32x16_bf16 v[64:79], v[40:43], v[248:251], v[64:79]
    ds_read_b64_tr_b16 v[60:61], v29 offset:12288
    ds_read_b64_tr_b16 v[62:63], v29 offset:13312
    v_mov_b32 v216, 0
    v_mov_b32 v217, 0
    v_mov_b32 v218, 0
    v_mov_b32 v219, 0
    s_waitcnt lgkmcnt(8)
    v_mfma_f32_32x32x16_bf16 v[64:79], v[44:47], v[252:255], v[64:79]
    ds_read_b64_tr_b16 v[32:33], v30 offset:0
    ds_read_b64_tr_b16 v[34:35], v30 offset:1024
    v_mov_b32 v220, 0
    v_mov_b32 v221, 0
    v_mov_b32 v222, 0
    v_mov_b32 v223, 0
    s_waitcnt lgkmcnt(8)
    v_mfma_f32_32x32x16_bf16 v[80:95], v[48:51], v[240:243], v[80:95]
    ds_read_b64_tr_b16 v[36:37], v30 offset:4096
    ds_read_b64_tr_b16 v[38:39], v30 offset:5120
    s_waitcnt lgkmcnt(8)
    v_mfma_f32_32x32x16_bf16 v[80:95], v[52:55], v[244:247], v[80:95]
    ds_read_b64_tr_b16 v[40:41], v30 offset:8192
    ds_read_b64_tr_b16 v[42:43], v30 offset:9216
    s_waitcnt lgkmcnt(8)
    v_mfma_f32_32x32x16_bf16 v[80:95], v[56:59], v[248:251], v[80:95]
    ds_read_b64_tr_b16 v[44:45], v30 offset:12288
    ds_read_b64_tr_b16 v[46:47], v30 offset:13312
    s_waitcnt lgkmcnt(8)
    v_mfma_f32_32x32x16_bf16 v[80:95], v[60:63], v[252:255], v[80:95]
    ds_read_b64_tr_b16 v[48:49], v31 offset:0
    ds_read_b64_tr_b16 v[50:51], v31 offset:1024
    v_mul_f32 v64, s44, v64
    v_mul_f32 v65, s44, v65
    v_mul_f32 v66, s44, v66
    v_mul_f32 v67, s44, v67
    s_waitcnt lgkmcnt(8)
    v_mfma_f32_32x32x16_bf16 v[96:111], v[32:35], v[240:243], v[96:111]
    ds_read_b64_tr_b16 v[52:53], v31 offset:4096
    ds_read_b64_tr_b16 v[54:55], v31 offset:5120
    v_mul_f32 v68, s44, v68
    v_mul_f32 v69, s44, v69
    v_mul_f32 v70, s44, v70
    v_mul_f32 v71, s44, v71
    s_waitcnt lgkmcnt(8)
    v_mfma_f32_32x32x16_bf16 v[96:111], v[36:39], v[244:247], v[96:111]
    ds_read_b64_tr_b16 v[56:57], v31 offset:8192
    ds_read_b64_tr_b16 v[58:59], v31 offset:9216
    v_mul_f32 v72, s44, v72
    v_mul_f32 v73, s44, v73
    v_mul_f32 v74, s44, v74
    v_mul_f32 v75, s44, v75
    s_waitcnt lgkmcnt(8)
    v_mfma_f32_32x32x16_bf16 v[96:111], v[40:43], v[248:251], v[96:111]
    ds_read_b64_tr_b16 v[60:61], v31 offset:12288
    ds_read_b64_tr_b16 v[62:63], v31 offset:13312
    v_mul_f32 v76, s44, v76
    v_mul_f32 v77, s44, v77
    v_mul_f32 v78, s44, v78
    v_mul_f32 v79, s44, v79
    s_waitcnt lgkmcnt(8)
    v_mfma_f32_32x32x16_bf16 v[96:111], v[44:47], v[252:255], v[96:111]
    v_mul_f32 v80, s44, v80
    v_mul_f32 v81, s44, v81
    v_mul_f32 v82, s44, v82
    v_mul_f32 v83, s44, v83
    s_waitcnt lgkmcnt(6)
    v_mfma_f32_32x32x16_bf16 v[112:127], v[48:51], v[240:243], v[112:127]
    v_mul_f32 v84, s44, v84
    v_mul_f32 v85, s44, v85
    v_mul_f32 v86, s44, v86
    v_mul_f32 v87, s44, v87
    s_waitcnt lgkmcnt(4)
    v_mfma_f32_32x32x16_bf16 v[112:127], v[52:55], v[244:247], v[112:127]
    v_mul_f32 v88, s44, v88
    v_mul_f32 v89, s44, v89
    v_mul_f32 v90, s44, v90
    v_mul_f32 v91, s44, v91
    s_waitcnt lgkmcnt(0)
    s_barrier
    ds_read_b128 v[224:227], v16 offset:0
    ds_read_b128 v[228:231], v17 offset:0
    ds_read_b128 v[232:235], v18 offset:0
    ds_read_b128 v[236:239], v19 offset:0
    v_mfma_f32_32x32x16_bf16 v[112:127], v[56:59], v[248:251], v[112:127]
    v_mul_f32 v92, s44, v92
    v_mul_f32 v93, s44, v93
    v_mul_f32 v94, s44, v94
    v_mul_f32 v95, s44, v95
    v_mfma_f32_32x32x16_bf16 v[112:127], v[60:63], v[252:255], v[112:127]
    v_cvt_pk_bf16_f32 v32, v64, v65
    v_cvt_pk_bf16_f32 v33, v66, v67
    v_cvt_pk_bf16_f32 v34, v68, v69
    v_cvt_pk_bf16_f32 v35, v70, v71
    v_cvt_pk_bf16_f32 v36, v72, v73
    v_cvt_pk_bf16_f32 v37, v74, v75
    v_cvt_pk_bf16_f32 v38, v76, v77
    v_cvt_pk_bf16_f32 v39, v78, v79
    v_cvt_pk_bf16_f32 v40, v80, v81
    v_cvt_pk_bf16_f32 v41, v82, v83
    v_cvt_pk_bf16_f32 v42, v84, v85
    v_cvt_pk_bf16_f32 v43, v86, v87
    v_cvt_pk_bf16_f32 v44, v88, v89
    v_cvt_pk_bf16_f32 v45, v90, v91
    v_cvt_pk_bf16_f32 v46, v92, v93
    v_cvt_pk_bf16_f32 v47, v94, v95
    v_mul_f32 v96, s44, v96
    v_mul_f32 v97, s44, v97
    v_mul_f32 v98, s44, v98
    v_mul_f32 v99, s44, v99
    v_mul_f32 v100, s44, v100
    v_mul_f32 v101, s44, v101
    v_mul_f32 v102, s44, v102
    v_mul_f32 v103, s44, v103
    v_mul_f32 v104, s44, v104
    v_mul_f32 v105, s44, v105
    v_mul_f32 v106, s44, v106
    v_mul_f32 v107, s44, v107
    v_mul_f32 v108, s44, v108
    v_mul_f32 v109, s44, v109
    v_mul_f32 v110, s44, v110
    v_mul_f32 v111, s44, v111
    v_cvt_pk_bf16_f32 v48, v96, v97
    v_cvt_pk_bf16_f32 v49, v98, v99
    v_cvt_pk_bf16_f32 v50, v100, v101
    v_cvt_pk_bf16_f32 v51, v102, v103
    v_cvt_pk_bf16_f32 v52, v104, v105
    v_cvt_pk_bf16_f32 v53, v106, v107
    v_cvt_pk_bf16_f32 v54, v108, v109
    v_cvt_pk_bf16_f32 v55, v110, v111
    ds_read_b128 v[240:243], v20 offset:0
    ds_read_b128 v[244:247], v21 offset:0
    v_mul_f32 v112, s44, v112
    v_mul_f32 v113, s44, v113
    v_mul_f32 v114, s44, v114
    v_mul_f32 v115, s44, v115
    v_mul_f32 v116, s44, v116
    v_mul_f32 v117, s44, v117
    v_mul_f32 v118, s44, v118
    v_mul_f32 v119, s44, v119
    v_mul_f32 v120, s44, v120
    v_mul_f32 v121, s44, v121
    v_mul_f32 v122, s44, v122
    v_mul_f32 v123, s44, v123
    v_mul_f32 v124, s44, v124
    v_mul_f32 v125, s44, v125
    v_mul_f32 v126, s44, v126
    v_mul_f32 v127, s44, v127
    v_cvt_pk_bf16_f32 v56, v112, v113
    v_cvt_pk_bf16_f32 v57, v114, v115
    v_cvt_pk_bf16_f32 v58, v116, v117
    v_cvt_pk_bf16_f32 v59, v118, v119
    v_cvt_pk_bf16_f32 v60, v120, v121
    v_cvt_pk_bf16_f32 v61, v122, v123
    v_cvt_pk_bf16_f32 v62, v124, v125
    v_cvt_pk_bf16_f32 v63, v126, v127
    s_mov_b32 s43, 0x4000
    s_waitcnt lgkmcnt(5)
    v_mfma_f32_32x32x16_bf16 v[128:143], v[224:227], v[32:35], v[208:223]
    ds_read_b128 v[248:251], v22 offset:0
    v_mov_b32 v64, 0
    v_mov_b32 v65, 0
    v_mov_b32 v66, 0
    v_mov_b32 v67, 0
    s_waitcnt lgkmcnt(5)
    v_mfma_f32_32x32x16_bf16 v[128:143], v[228:231], v[36:39], v[128:143]
    ds_read_b128 v[252:255], v23 offset:0
    v_mov_b32 v68, 0
    v_mov_b32 v69, 0
    v_mov_b32 v70, 0
    v_mov_b32 v71, 0
    s_waitcnt lgkmcnt(5)
    v_mfma_f32_32x32x16_bf16 v[128:143], v[232:235], v[40:43], v[128:143]
    ds_read_b128 v[224:227], v16 offset:8192
    v_mov_b32 v72, 0
    v_mov_b32 v73, 0
    v_mov_b32 v74, 0
    v_mov_b32 v75, 0
    s_waitcnt lgkmcnt(5)
    v_mfma_f32_32x32x16_bf16 v[128:143], v[236:239], v[44:47], v[128:143]
    ds_read_b128 v[228:231], v17 offset:8192
    v_mov_b32 v76, 0
    v_mov_b32 v77, 0
    v_mov_b32 v78, 0
    v_mov_b32 v79, 0
    s_waitcnt lgkmcnt(5)
    v_mfma_f32_32x32x16_bf16 v[128:143], v[240:243], v[48:51], v[128:143]
    ds_read_b128 v[232:235], v18 offset:8192
    v_mov_b32 v80, 0
    v_mov_b32 v81, 0
    v_mov_b32 v82, 0
    v_mov_b32 v83, 0
    s_waitcnt lgkmcnt(5)
    v_mfma_f32_32x32x16_bf16 v[128:143], v[244:247], v[52:55], v[128:143]
    ds_read_b128 v[236:239], v19 offset:8192
    v_mov_b32 v84, 0
    v_mov_b32 v85, 0
    v_mov_b32 v86, 0
    v_mov_b32 v87, 0
    s_waitcnt lgkmcnt(5)
    v_mfma_f32_32x32x16_bf16 v[128:143], v[248:251], v[56:59], v[128:143]
    ds_read_b128 v[240:243], v20 offset:8192
    v_mov_b32 v88, 0
    v_mov_b32 v89, 0
    v_mov_b32 v90, 0
    v_mov_b32 v91, 0
    s_waitcnt lgkmcnt(5)
    v_mfma_f32_32x32x16_bf16 v[128:143], v[252:255], v[60:63], v[128:143]
    ds_read_b128 v[244:247], v21 offset:8192
    v_mov_b32 v92, 0
    v_mov_b32 v93, 0
    v_mov_b32 v94, 0
    v_mov_b32 v95, 0
    s_waitcnt lgkmcnt(5)
    v_mfma_f32_32x32x16_bf16 v[144:159], v[224:227], v[32:35], v[208:223]
    ds_read_b128 v[248:251], v22 offset:8192
    v_mov_b32 v96, 0
    v_mov_b32 v97, 0
    v_mov_b32 v98, 0
    v_mov_b32 v99, 0
    s_waitcnt lgkmcnt(5)
    v_mfma_f32_32x32x16_bf16 v[144:159], v[228:231], v[36:39], v[144:159]
    ds_read_b128 v[252:255], v23 offset:8192
    v_mov_b32 v100, 0
    v_mov_b32 v101, 0
    v_mov_b32 v102, 0
    v_mov_b32 v103, 0
    s_waitcnt lgkmcnt(5)
    v_mfma_f32_32x32x16_bf16 v[144:159], v[232:235], v[40:43], v[144:159]
    v_mov_b32 v104, 0
    v_mov_b32 v105, 0
    v_mov_b32 v106, 0
    v_mov_b32 v107, 0
    s_waitcnt lgkmcnt(4)
    v_mfma_f32_32x32x16_bf16 v[144:159], v[236:239], v[44:47], v[144:159]
    v_mov_b32 v108, 0
    v_mov_b32 v109, 0
    v_mov_b32 v110, 0
    v_mov_b32 v111, 0
    s_waitcnt lgkmcnt(3)
    v_mfma_f32_32x32x16_bf16 v[144:159], v[240:243], v[48:51], v[144:159]
    v_mov_b32 v112, 0
    v_mov_b32 v113, 0
    v_mov_b32 v114, 0
    v_mov_b32 v115, 0
    s_waitcnt lgkmcnt(2)
    v_mfma_f32_32x32x16_bf16 v[144:159], v[244:247], v[52:55], v[144:159]
    v_mov_b32 v116, 0
    v_mov_b32 v117, 0
    v_mov_b32 v118, 0
    v_mov_b32 v119, 0
    s_waitcnt lgkmcnt(1)
    v_mfma_f32_32x32x16_bf16 v[144:159], v[248:251], v[56:59], v[144:159]
    v_mov_b32 v120, 0
    v_mov_b32 v121, 0
    v_mov_b32 v122, 0
    v_mov_b32 v123, 0
    s_waitcnt lgkmcnt(0)
    v_mfma_f32_32x32x16_bf16 v[144:159], v[252:255], v[60:63], v[144:159]
    v_mov_b32 v124, 0
    v_mov_b32 v125, 0
    v_mov_b32 v126, 0
    v_mov_b32 v127, 0
    v_mov_b32 v8, 0
    v_mov_b32 v9, 0
    s_mov_b32 s68, 0xff800000
    s_mov_b32 s69, 0xff800000
    v_add_u32 v16, 0x4000, v16
    v_add_u32 v17, 0x4000, v17
    v_add_u32 v18, 0x4000, v18
    v_add_u32 v19, 0x4000, v19
    v_add_u32 v20, 0x4000, v20
    v_add_u32 v21, 0x4000, v21
    v_add_u32 v22, 0x4000, v22
    v_add_u32 v23, 0x4000, v23
    s_mov_b32 s46, 2
    s_mov_b32 s47, 0x4000
    s_mov_b32 s48, 0x4000
    s_mov_b32 s45, 0
    s_waitcnt vmcnt(0) lgkmcnt(0)
    s_cmp_lg_u32 s74, 0
    s_cbranch_scc1 L_nl
    s_lshl_b32 s41, s37, 2
    buffer_load_dword v12, v6, s[88:91], s41 offen sc1
L_nl:
    s_barrier
    ds_read_b128 v[224:227], v16 offset:0
    ds_read_b128 v[228:231], v17 offset:0
    ds_read_b128 v[232:235], v18 offset:0
    ds_read_b128 v[236:239], v19 offset:0
    ds_read_b128 v[240:243], v20 offset:0
    ds_read_b128 v[244:247], v21 offset:0
    v_max3_f32 v11, v128, v129, v130
    v_max3_f32 v11, v131, v132, v11
    v_max3_f32 v11, v133, v134, v11
    v_max3_f32 v11, v135, v136, v11
    v_max3_f32 v11, v137, v138, v11
    v_max3_f32 v11, v139, v140, v11
    v_max3_f32 v11, v141, v142, v11
    v_max3_f32 v11, v143, v144, v11
    v_max3_f32 v11, v145, v146, v11
    v_max3_f32 v11, v147, v148, v11
    v_max3_f32 v11, v149, v150, v11
    v_max3_f32 v11, v151, v152, v11
    v_max3_f32 v11, v153, v154, v11
    v_max3_f32 v11, v155, v156, v11
    v_max3_f32 v11, v157, v158, v11
    v_max_f32 v11, v159, v11
    s_nop 4
    s_branch L_chkA
L_loop:
    s_waitcnt lgkmcnt(4)
    v_mfma_f32_32x32x16_bf16 v[160:175], v[224:227], v[32:35], v[208:223]
    ds_read_b128 v[248:251], v22 offset:0
    v_exp_f32 v128, v128
    v_exp_f32 v129, v129
    v_mfma_f32_32x32x16_bf16 v[160:175], v[228:231], v[36:39], v[160:175]
    ds_read_b128 v[252:255], v23 offset:0
    v_cvt_pk_bf16_f32 v192, v128, v129
    v_exp_f32 v130, v130
    v_exp_f32 v131, v131
    s_waitcnt lgkmcnt(4)
    v_mfma_f32_32x32x16_bf16 v[160:175], v[232:235], v[40:43], v[160:175]
    ds_read_b128 v[224:227], v16 offset:8192
    v_cvt_pk_bf16_f32 v193, v130, v131
    v_exp_f32 v132, v132
    v_exp_f32 v133, v133
    v_mfma_f32_32x32x16_bf16 v[160:175], v[236:239], v[44:47], v[160:175]
    ds_read_b128 v[228:231], v17 offset:8192
    v_cvt_pk_bf16_f32 v194, v132, v133
    v_exp_f32 v134, v134
    v_exp_f32 v135, v135
    s_waitcnt lgkmcnt(4)
    v_mfma_f32_32x32x16_bf16 v[160:175], v[240:243], v[48:51], v[160:175]
    ds_read_b128 v[232:235], v18 offset:8192
    v_cvt_pk_bf16_f32 v195, v134, v135
    v_exp_f32 v136, v136
    v_exp_f32 v137, v137
    v_mfma_f32_32x32x16_bf16 v[160:175], v[244:247], v[52:55], v[160:175]
    ds_read_b128 v[236:239], v19 offset:8192
    v_cvt_pk_bf16_f32 v196, v136, v137
    v_exp_f32 v138, v138
    v_exp_f32 v139, v139
    s_waitcnt lgkmcnt(4)
    v_mfma_f32_32x32x16_bf16 v[160:175], v[248:251], v[56:59], v[160:175]
    ds_read_b128 v[240:243], v20 offset:8192
    v_cvt_pk_bf16_f32 v197, v138, v139
    v_exp_f32 v140, v140
    v_exp_f32 v141, v141
    v_mfma_f32_32x32x16_bf16 v[160:175], v[252:255], v[60:63], v[160:175]
    ds_read_b128 v[244:247], v21 offset:8192
    v_cvt_pk_bf16_f32 v198, v140, v141
    v_exp_f32 v142, v142
    v_exp_f32 v143, v143
    s_waitcnt lgkmcnt(4)
    v_mfma_f32_32x32x16_bf16 v[176:191], v[224:227], v[32:35], v[208:223]
    ds_read_b128 v[248:251], v22 offset:8192
    v_cvt_pk_bf16_f32 v199, v142, v143
    v_exp_f32 v144, v144
    v_exp_f32 v145, v145
    v_mfma_f32_32x32x16_bf16 v[176:191], v[228:231], v[36:39], v[176:191]
    ds_read_b128 v[252:255], v23 offset:8192
    v_cvt_pk_bf16_f32 v200, v144, v145
    v_exp_f32 v146, v146
    v_exp_f32 v147, v147
    s_waitcnt lgkmcnt(4)
    v_mfma_f32_32x32x16_bf16 v[176:191], v[232:235], v[40:43], v[176:191]
    ds_read_b64_tr_b16 v[224:225], v24 offset:0
    ds_read_b64_tr_b16 v[226:227], v24 offset:2048
    v_cvt_pk_bf16_f32 v201, v146, v147
    v_exp_f32 v148, v148
    v_exp_f32 v149, v149
    v_mfma_f32_32x32x16_bf16 v[176:191], v[236:239], v[44:47], v[176:191]
    ds_read_b64_tr_b16 v[228:229], v25 offset:0
    ds_read_b64_tr_b16 v[230:231], v25 offset:2048
    v_cvt_pk_bf16_f32 v202, v148, v149
    v_exp_f32 v150, v150
    v_exp_f32 v151, v151
    s_waitcnt lgkmcnt(6)
    v_mfma_f32_32x32x16_bf16 v[176:191], v[240:243], v[48:51], v[176:191]
    ds_read_b64_tr_b16 v[232:233], v26 offset:0
    ds_read_b64_tr_b16 v[234:235], v26 offset:2048
    v_cvt_pk_bf16_f32 v203, v150, v151
    v_exp_f32 v152, v152
    v_exp_f32 v153, v153
    v_mfma_f32_32x32x16_bf16 v[176:191], v[244:247], v[52:55], v[176:191]
    ds_read_b64_tr_b16 v[236:237], v27 offset:0
    ds_read_b64_tr_b16 v[238:239], v27 offset:2048
    v_cvt_pk_bf16_f32 v204, v152, v153
    v_exp_f32 v154, v154
    v_exp_f32 v155, v155
    s_waitcnt lgkmcnt(8)
    v_mfma_f32_32x32x16_bf16 v[176:191], v[248:251], v[56:59], v[176:191]
    ds_read_b64_tr_b16 v[240:241], v24 offset:4096
    ds_read_b64_tr_b16 v[242:243], v24 offset:6144
    v_cvt_pk_bf16_f32 v205, v154, v155
    v_exp_f32 v156, v156
    v_exp_f32 v157, v157
    v_mfma_f32_32x32x16_bf16 v[176:191], v[252:255], v[60:63], v[176:191]
    ds_read_b64_tr_b16 v[244:245], v25 offset:4096
    ds_read_b64_tr_b16 v[246:247], v25 offset:6144
    v_cvt_pk_bf16_f32 v206, v156, v157
    v_exp_f32 v158, v158
    v_exp_f32 v159, v159
    s_waitcnt lgkmcnt(8)
    v_mfma_f32_32x32x16_bf16 v[64:79], v[224:227], v[192:195], v[64:79]
    ds_read_b64_tr_b16 v[248:249], v26 offset:4096
    ds_read_b64_tr_b16 v[250:251], v26 offset:6144
    v_cvt_pk_bf16_f32 v207, v158, v159
    v_add_f32 v8, v8, v128
    v_add_f32 v9, v9, v129
    v_max3_f32 v11, v160, v161, v162
    v_mfma_f32_32x32x16_bf16 v[80:95], v[228:231], v[192:195], v[80:95]
    ds_read_b64_tr_b16 v[252:253], v27 offset:4096
    ds_read_b64_tr_b16 v[254:255], v27 offset:6144
    v_add_f32 v8, v8, v130
    v_add_f32 v9, v9, v131
    v_max3_f32 v11, v163, v164, v11
    s_waitcnt lgkmcnt(8)
    v_mfma_f32_32x32x16_bf16 v[96:111], v[232:235], v[192:195], v[96:111]
    ds_read_b64_tr_b16 v[224:225], v24 offset:8192
    ds_read_b64_tr_b16 v[226:227], v24 offset:10240
    v_add_f32 v8, v8, v132
    v_add_f32 v9, v9, v133
    v_max3_f32 v11, v165, v166, v11
    v_add_u32 v16, s47, v16
    v_mfma_f32_32x32x16_bf16 v[112:127], v[236:239], v[192:195], v[112:127]
    ds_read_b64_tr_b16 v[228:229], v25 offset:8192
    ds_read_b64_tr_b16 v[230:231], v25 offset:10240
    v_add_f32 v8, v8, v134
    v_add_f32 v9, v9, v135
    v_max3_f32 v11, v167, v168, v11
    v_add_u32 v17, s47, v17
    s_waitcnt lgkmcnt(8)
    v_mfma_f32_32x32x16_bf16 v[64:79], v[240:243], v[196:199], v[64:79]
    ds_read_b64_tr_b16 v[232:233], v26 offset:8192
    ds_read_b64_tr_b16 v[234:235], v26 offset:10240
    v_add_f32 v8, v8, v136
    v_add_f32 v9, v9, v137
    v_max3_f32 v11, v169, v170, v11
    v_add_u32 v18, s47, v18
    v_mfma_f32_32x32x16_bf16 v[80:95], v[244:247], v[196:199], v[80:95]
    ds_read_b64_tr_b16 v[236:237], v27 offset:8192
    ds_read_b64_tr_b16 v[238:239], v27 offset:10240
    v_add_f32 v8, v8, v138
    v_add_f32 v9, v9, v139
    v_max3_f32 v11, v171, v172, v11
    v_add_u32 v19, s47, v19
    s_waitcnt lgkmcnt(8)
    v_mfma_f32_32x32x16_bf16 v[96:111], v[248:251], v[196:199], v[96:111]
    ds_read_b64_tr_b16 v[240:241], v24 offset:12288
    ds_read_b64_tr_b16 v[242:243], v24 offset:14336
    v_add_f32 v8, v8, v140
    v_add_f32 v9, v9, v141
    v_max3_f32 v11, v173, v174, v11
    v_add_u32 v20, s47, v20
    v_mfma_f32_32x32x16_bf16 v[112:127], v[252:255], v[196:199], v[112:127]
    ds_read_b64_tr_b16 v[244:245], v25 offset:12288
    ds_read_b64_tr_b16 v[246:247], v25 offset:14336
    v_add_f32 v8, v8, v142
    v_add_f32 v9, v9, v143
    v_max3_f32 v11, v175, v176, v11
    v_add_u32 v21, s47, v21
    s_waitcnt lgkmcnt(8)
    v_mfma_f32_32x32x16_bf16 v[64:79], v[224:227], v[200:203], v[64:79]
    ds_read_b64_tr_b16 v[248:249], v26 offset:12288
    ds_read_b64_tr_b16 v[250:251], v26 offset:14336
    v_add_f32 v8, v8, v144
    v_add_f32 v9, v9, v145
    v_max3_f32 v11, v177, v178, v11
    v_add_u32 v22, s47, v22
    v_mfma_f32_32x32x16_bf16 v[80:95], v[228:231], v[200:203], v[80:95]
    ds_read_b64_tr_b16 v[252:253], v27 offset:12288
    ds_read_b64_tr_b16 v[254:255], v27 offset:14336
    v_add_f32 v8, v8, v146
    v_add_f32 v9, v9, v147
    v_max3_f32 v11, v179, v180, v11
    v_add_u32 v23, s47, v23
    s_waitcnt lgkmcnt(8)
    v_mfma_f32_32x32x16_bf16 v[96:111], v[232:235], v[200:203], v[96:111]
    v_add_f32 v8, v8, v148
    v_add_f32 v9, v9, v149
    v_max3_f32 v11, v181, v182, v11
    v_add_u32 v24, s48, v24
    v_add_u32 v25, s48, v25
    v_mfma_f32_32x32x16_bf16 v[112:127], v[236:239], v[200:203], v[112:127]
    v_add_f32 v8, v8, v150
    v_add_f32 v9, v9, v151
    v_max3_f32 v11, v183, v184, v11
    v_add_u32 v26, s48, v26
    v_add_u32 v27, s48, v27
    s_waitcnt lgkmcnt(4)
    v_mfma_f32_32x32x16_bf16 v[64:79], v[240:243], v[204:207], v[64:79]
    v_add_f32 v8, v8, v152
    v_add_f32 v9, v9, v153
    v_max3_f32 v11, v185, v186, v11
    s_mov_b32 s48, s47
    s_add_u32 s46, s46, 1
    s_cmp_eq_u32 s46, 3
    s_cselect_b32 s46, 0, s46
    s_cselect_b32 s47, 0xffff8000, s43
    s_waitcnt lgkmcnt(0)
    s_barrier
    ds_read_b128 v[224:227], v16 offset:0
    ds_read_b128 v[228:231], v17 offset:0
    ds_read_b128 v[232:235], v18 offset:0
    v_mfma_f32_32x32x16_bf16 v[80:95], v[244:247], v[204:207], v[80:95]
    v_add_f32 v8, v8, v154
    v_add_f32 v9, v9, v155
    v_max3_f32 v11, v187, v188, v11
    ds_read_b128 v[236:239], v19 offset:0
    v_mfma_f32_32x32x16_bf16 v[96:111], v[248:251], v[204:207], v[96:111]
    v_add_f32 v8, v8, v156
    v_add_f32 v9, v9, v157
    v_max3_f32 v11, v189, v190, v11
    ds_read_b128 v[240:243], v20 offset:0
    v_mfma_f32_32x32x16_bf16 v[112:127], v[252:255], v[204:207], v[112:127]
    v_add_f32 v8, v8, v158
    v_add_f32 v9, v9, v159
    v_max_f32 v11, v191, v11
    ds_read_b128 v[244:247], v21 offset:0
    v_cmp_lt_f32 vcc, s68, v11
    s_nop 1
    s_cbranch_vccnz L_rareB
L_rareB_ret:
    s_cmp_lg_u32 s45, 3
    s_cbranch_scc1 L_h1
    ds_read_b128 v[32:35], v14 offset:0
    ds_read_b128 v[36:39], v14 offset:1024
    ds_read_b128 v[40:43], v14 offset:2048
    ds_read_b128 v[44:47], v14 offset:3072
    ds_read_b128 v[48:51], v14 offset:4096
    ds_read_b128 v[52:55], v14 offset:5120
    ds_read_b128 v[56:59], v14 offset:6144
    ds_read_b128 v[60:63], v14 offset:7168
    v_mov_b32 v208, 0
    v_mov_b32 v209, 0
    v_mov_b32 v210, 0
    v_mov_b32 v211, 0
    v_mov_b32 v212, 0
    v_mov_b32 v213, 0
    v_mov_b32 v214, 0
    v_mov_b32 v215, 0
    v_mov_b32 v216, 0
    v_mov_b32 v217, 0
    v_mov_b32 v218, 0
    v_mov_b32 v219, 0
    v_mov_b32 v220, 0
    v_mov_b32 v221, 0
    v_mov_b32 v222, 0
    v_mov_b32 v223, 0
    s_waitcnt lgkmcnt(0)
    s_nop 3
L_h1:
    s_cmp_lg_u32 s45, s39
    s_cbranch_scc1 L_h2
    v_mov_b32 v2, s98
    s_lshl_b32 s41, s87, 2
    s_add_u32 s41, s41, s86
    s_mov_b64 exec, 1
    buffer_store_dword v2, v6, s[24:27], s41 offen sc1
    s_mov_b64 exec, -1
L_h2:
    s_cmp_lg_u32 s45, 4
    s_cbranch_scc1 L_h3
    v_mov_b32 v2, 0x24000
    ds_read_b32 v3, v2
    s_waitcnt lgkmcnt(0)
    v_readfirstlane_b32 s98, v3
    s_nop 4
L_h3:
    s_waitcnt lgkmcnt(4)
    v_mfma_f32_32x32x16_bf16 v[128:143], v[224:227], v[32:35], v[208:223]
    ds_read_b128 v[248:251], v22 offset:0
    v_exp_f32 v160, v160
    v_exp_f32 v161, v161
    v_mfma_f32_32x32x16_bf16 v[128:143], v[228:231], v[36:39], v[128:143]
    ds_read_b128 v[252:255], v23 offset:0
    v_cvt_pk_bf16_f32 v192, v160, v161
    v_exp_f32 v162, v162
    v_exp_f32 v163, v163
    s_waitcnt lgkmcnt(4)
    v_mfma_f32_32x32x16_bf16 v[128:143], v[232:235], v[40:43], v[128:143]
    ds_read_b128 v[224:227], v16 offset:8192
    v_cvt_pk_bf16_f32 v193, v162, v163
    v_exp_f32 v164, v164
    v_exp_f32 v165, v165
    v_mfma_f32_32x32x16_bf16 v[128:143], v[236:239], v[44:47], v[128:143]
    ds_read_b128 v[228:231], v17 offset:8192
    v_cvt_pk_bf16_f32 v194, v164, v165
    v_exp_f32 v166, v166
    v_exp_f32 v167, v167
    s_waitcnt lgkmcnt(4)
    v_mfma_f32_32x32x16_bf16 v[128:143], v[240:243], v[48:51], v[128:143]
    ds_read_b128 v[232:235], v18 offset:8192
    v_cvt_pk_bf16_f32 v195, v166, v167
    v_exp_f32 v168, v168
    v_exp_f32 v169, v169
    v_mfma_f32_32x32x16_bf16 v[128:143], v[244:247], v[52:55], v[128:143]
    ds_read_b128 v[236:239], v19 offset:8192
    v_cvt_pk_bf16_f32 v196, v168, v169
    v_exp_f32 v170, v170
    v_exp_f32 v171, v171
    s_waitcnt lgkmcnt(4)
    v_mfma_f32_32x32x16_bf16 v[128:143], v[248:251], v[56:59], v[128:143]
    ds_read_b128 v[240:243], v20 offset:8192
    v_cvt_pk_bf16_f32 v197, v170, v171
    v_exp_f32 v172, v172
    v_exp_f32 v173, v173
    v_mfma_f32_32x32x16_bf16 v[128:143], v[252:255], v[60:63], v[128:143]
    ds_read_b128 v[244:247], v21 offset:8192
    v_cvt_pk_bf16_f32 v198, v172, v173
    v_exp_f32 v174, v174
    v_exp_f32 v175, v175
    s_waitcnt lgkmcnt(4)
    v_mfma_f32_32x32x16_bf16 v[144:159], v[224:227], v[32:35], v[208:223]
    ds_read_b128 v[248:251], v22 offset:8192
    v_cvt_pk_bf16_f32 v199, v174, v175
    v_exp_f32 v176, v176
    v_exp_f32 v177, v177
    v_mfma_f32_32x32x16_bf16 v[144:159], v[228:231], v[36:39], v[144:159]
    ds_read_b128 v[252:255], v23 offset:8192
    v_cvt_pk_bf16_f32 v200, v176, v177
    v_exp_f32 v178, v178
    v_exp_f32 v179, v179
    s_waitcnt lgkmcnt(4)
    v_mfma_f32_32x32x16_bf16 v[144:159], v[232:235], v[40:43], v[144:159]
    ds_read_b64_tr_b16 v[224:225], v24 offset:0
    ds_read_b64_tr_b16 v[226:227], v24 offset:2048
    v_cvt_pk_bf16_f32 v201, v178, v179
    v_exp_f32 v180, v180
    v_exp_f32 v181, v181
    v_mfma_f32_32x32x16_bf16 v[144:159], v[236:239], v[44:47], v[144:159]
    ds_read_b64_tr_b16 v[228:229], v25 offset:0
    ds_read_b64_tr_b16 v[230:231], v25 offset:2048
    v_cvt_pk_bf16_f32 v202, v180, v181
    v_exp_f32 v182, v182
    v_exp_f32 v183, v183
    s_waitcnt lgkmcnt(6)
    v_mfma_f32_32x32x16_bf16 v[144:159], v[240:243], v[48:51], v[144:159]
    ds_read_b64_tr_b16 v[232:233], v26 offset:0
    ds_read_b64_tr_b16 v[234:235], v26 offset:2048
    v_cvt_pk_bf16_f32 v203, v182, v183
    v_exp_f32 v184, v184
    v_exp_f32 v185, v185
    v_mfma_f32_32x32x16_bf16 v[144:159], v[244:247], v[52:55], v[144:159]
    ds_read_b64_tr_b16 v[236:237], v27 offset:0
    ds_read_b64_tr_b16 v[238:239], v27 offset:2048
    v_cvt_pk_bf16_f32 v204, v184, v185
    v_exp_f32 v186, v186
    v_exp_f32 v187, v187
    s_waitcnt lgkmcnt(8)
    v_mfma_f32_32x32x16_bf16 v[144:159], v[248:251], v[56:59], v[144:159]
    ds_read_b64_tr_b16 v[240:241], v24 offset:4096
    ds_read_b64_tr_b16 v[242:243], v24 offset:6144
    v_cvt_pk_bf16_f32 v205, v186, v187
    v_exp_f32 v188, v188
    v_exp_f32 v189, v189
    v_mfma_f32_32x32x16_bf16 v[144:159], v[252:255], v[60:63], v[144:159]
    ds_read_b64_tr_b16 v[244:245], v25 offset:4096
    ds_read_b64_tr_b16 v[246:247], v25 offset:6144
    v_cvt_pk_bf16_f32 v206, v188, v189
    v_exp_f32 v190, v190
    v_exp_f32 v191, v191
    s_waitcnt lgkmcnt(8)
    v_mfma_f32_32x32x16_bf16 v[64:79], v[224:227], v[192:195], v[64:79]
    ds_read_b64_tr_b16 v[248:249], v26 offset:4096
    ds_read_b64_tr_b16 v[250:251], v26 offset:6144
    v_cvt_pk_bf16_f32 v207, v190, v191
    v_add_f32 v8, v8, v160
    v_add_f32 v9, v9, v161
    v_max3_f32 v11, v128, v129, v130
    v_mfma_f32_32x32x16_bf16 v[80:95], v[228:231], v[192:195], v[80:95]
    ds_read_b64_tr_b16 v[252:253], v27 offset:4096
    ds_read_b64_tr_b16 v[254:255], v27 offset:6144
    v_add_f32 v8, v8, v162
    v_add_f32 v9, v9, v163
    v_max3_f32 v11, v131, v132, v11
    s_waitcnt lgkmcnt(8)
    v_mfma_f32_32x32x16_bf16 v[96:111], v[232:235], v[192:195], v[96:111]
    ds_read_b64_tr_b16 v[224:225], v24 offset:8192
    ds_read_b64_tr_b16 v[226:227], v24 offset:10240
    v_add_f32 v8, v8, v164
    v_add_f32 v9, v9, v165
    v_max3_f32 v11, v133, v134, v11
    v_add_u32 v16, s47, v16
    v_mfma_f32_32x32x16_bf16 v[112:127], v[236:239], v[192:195], v[112:127]
    ds_read_b64_tr_b16 v[228:229], v25 offset:8192
    ds_read_b64_tr_b16 v[230:231], v25 offset:10240
    v_add_f32 v8, v8, v166
    v_add_f32 v9, v9, v167
    v_max3_f32 v11, v135, v136, v11
    v_add_u32 v17, s47, v17
    s_waitcnt lgkmcnt(8)
    v_mfma_f32_32x32x16_bf16 v[64:79], v[240:243], v[196:199], v[64:79]
    ds_read_b64_tr_b16 v[232:233], v26 offset:8192
    ds_read_b64_tr_b16 v[234:235], v26 offset:10240
    v_add_f32 v8, v8, v168
    v_add_f32 v9, v9, v169
    v_max3_f32 v11, v137, v138, v11
    v_add_u32 v18, s47, v18
    v_mfma_f32_32x32x16_bf16 v[80:95], v[244:247], v[196:199], v[80:95]
    ds_read_b64_tr_b16 v[236:237], v27 offset:8192
    ds_read_b64_tr_b16 v[238:239], v27 offset:10240
    v_add_f32 v8, v8, v170
    v_add_f32 v9, v9, v171
    v_max3_f32 v11, v139, v140, v11
    v_add_u32 v19, s47, v19
    s_waitcnt lgkmcnt(8)
    v_mfma_f32_32x32x16_bf16 v[96:111], v[248:251], v[196:199], v[96:111]
    ds_read_b64_tr_b16 v[240:241], v24 offset:12288
    ds_read_b64_tr_b16 v[242:243], v24 offset:14336
    v_add_f32 v8, v8, v172
    v_add_f32 v9, v9, v173
    v_max3_f32 v11, v141, v142, v11
    v_add_u32 v20, s47, v20
    v_mfma_f32_32x32x16_bf16 v[112:127], v[252:255], v[196:199], v[112:127]
    ds_read_b64_tr_b16 v[244:245], v25 offset:12288
    ds_read_b64_tr_b16 v[246:247], v25 offset:14336
    v_add_f32 v8, v8, v174
    v_add_f32 v9, v9, v175
    v_max3_f32 v11, v143, v144, v11
    v_add_u32 v21, s47, v21
    s_waitcnt lgkmcnt(8)
    v_mfma_f32_32x32x16_bf16 v[64:79], v[224:227], v[200:203], v[64:79]
    ds_read_b64_tr_b16 v[248:249], v26 offset:12288
    ds_read_b64_tr_b16 v[250:251], v26 offset:14336
    v_add_f32 v8, v8, v176
    v_add_f32 v9, v9, v177
    v_max3_f32 v11, v145, v146, v11
    v_add_u32 v22, s47, v22
    v_mfma_f32_32x32x16_bf16 v[80:95], v[228:231], v[200:203], v[80:95]
    ds_read_b64_tr_b16 v[252:253], v27 offset:12288
    ds_read_b64_tr_b16 v[254:255], v27 offset:14336
    v_add_f32 v8, v8, v178
    v_add_f32 v9, v9, v179
    v_max3_f32 v11, v147, v148, v11
    v_add_u32 v23, s47, v23
    s_waitcnt lgkmcnt(8)
    v_mfma_f32_32x32x16_bf16 v[96:111], v[232:235], v[200:203], v[96:111]
    v_add_f32 v8, v8, v180
    v_add_f32 v9, v9, v181
    v_max3_f32 v11, v149, v150, v11
    v_add_u32 v24, s48, v24
    v_add_u32 v25, s48, v25
    v_mfma_f32_32x32x16_bf16 v[112:127], v[236:239], v[200:203], v[112:127]
    v_add_f32 v8, v8, v182
    v_add_f32 v9, v9, v183
    v_max3_f32 v11, v151, v152, v11
    v_add_u32 v26, s48, v26
    v_add_u32 v27, s48, v27
    s_waitcnt lgkmcnt(4)
    v_mfma_f32_32x32x16_bf16 v[64:79], v[240:243], v[204:207], v[64:79]
    v_add_f32 v8, v8, v184
    v_add_f32 v9, v9, v185
    v_max3_f32 v11, v153, v154, v11
    s_mov_b32 s48, s47
    s_add_u32 s46, s46, 1
    s_cmp_eq_u32 s46, 3
    s_cselect_b32 s46, 0, s46
    s_cselect_b32 s47, 0xffff8000, s43
    s_waitcnt lgkmcnt(0)
    s_barrier
    ds_read_b128 v[224:227], v16 offset:0
    ds_read_b128 v[228:231], v17 offset:0
    ds_read_b128 v[232:235], v18 offset:0
    v_mfma_f32_32x32x16_bf16 v[80:95], v[244:247], v[204:207], v[80:95]
    v_add_f32 v8, v8, v186
    v_add_f32 v9, v9, v187
    v_max3_f32 v11, v155, v156, v11
    ds_read_b128 v[236:239], v19 offset:0
    v_mfma_f32_32x32x16_bf16 v[96:111], v[248:251], v[204:207], v[96:111]
    v_add_f32 v8, v8, v188
    v_add_f32 v9, v9, v189
    v_max3_f32 v11, v157, v158, v11
    ds_read_b128 v[240:243], v20 offset:0
    v_mfma_f32_32x32x16_bf16 v[112:127], v[252:255], v[204:207], v[112:127]
    v_add_f32 v8, v8, v190
    v_add_f32 v9, v9, v191
    v_max_f32 v11, v159, v11
    ds_read_b128 v[244:247], v21 offset:0
    s_add_u32 s45, s45, 1
    s_and_b32 s41, s45, 3
    s_cbranch_scc0 L_epi
L_chkA:
    v_cmp_lt_f32 vcc, s68, v11
    s_nop 1
    s_cbranch_vccnz L_rareA
L_rareA_ret:
    s_branch L_loop
L_rareA:
    v_mov_b32 v3, v11
    s_nop 1
    v_permlane32_swap_b32 v11, v3
    v_max3_f32 v11, v11, v3, s69
    v_sub_f32 v128, v128, v11
    v_sub_f32 v129, v129, v11
    v_sub_f32 v130, v130, v11
    v_sub_f32 v131, v131, v11
    v_sub_f32 v132, v132, v11
    v_sub_f32 v133, v133, v11
    v_sub_f32 v134, v134, v11
    v_sub_f32 v135, v135, v11
    v_sub_f32 v136, v136, v11
    v_sub_f32 v137, v137, v11
    v_sub_f32 v138, v138, v11
    v_sub_f32 v139, v139, v11
    v_sub_f32 v140, v140, v11
    v_sub_f32 v141, v141, v11
    v_sub_f32 v142, v142, v11
    v_sub_f32 v143, v143, v11
    v_sub_f32 v144, v144, v11
    v_sub_f32 v145, v145, v11
    v_sub_f32 v146, v146, v11
    v_sub_f32 v147, v147, v11
    v_sub_f32 v148, v148, v11
    v_sub_f32 v149, v149, v11
    v_sub_f32 v150, v150, v11
    v_sub_f32 v151, v151, v11
    v_sub_f32 v152, v152, v11
    v_sub_f32 v153, v153, v11
    v_sub_f32 v154, v154, v11
    v_sub_f32 v155, v155, v11
    v_sub_f32 v156, v156, v11
    v_sub_f32 v157, v157, v11
    v_sub_f32 v158, v158, v11
    v_sub_f32 v159, v159, v11
    v_sub_f32 v208, v208, v11
    v_sub_f32 v209, v209, v11
    v_sub_f32 v210, v210, v11
    v_sub_f32 v211, v211, v11
    v_sub_f32 v212, v212, v11
    v_sub_f32 v213, v213, v11
    v_sub_f32 v214, v214, v11
    v_sub_f32 v215, v215, v11
    v_sub_f32 v216, v216, v11
    v_sub_f32 v217, v217, v11
    v_sub_f32 v218, v218, v11
    v_sub_f32 v219, v219, v11
    v_sub_f32 v220, v220, v11
    v_sub_f32 v221, v221, v11
    v_sub_f32 v222, v222, v11
    v_sub_f32 v223, v223, v11
    s_cmp_lg_u32 s69, 0
    s_mov_b32 s68, 0x41000000
    s_mov_b32 s69, 0
    s_cbranch_scc1 L_rareA_ret
    v_sub_f32 v10, 0, v11
    v_exp_f32 v10, v10
    s_nop 0
    v_mul_f32 v8, v10, v8
    v_mul_f32 v9, v10, v9
    v_mul_f32 v64, v10, v64
    v_mul_f32 v65, v10, v65
    v_mul_f32 v66, v10, v66
    v_mul_f32 v67, v10, v67
    v_mul_f32 v68, v10, v68
    v_mul_f32 v69, v10, v69
    v_mul_f32 v70, v10, v70
    v_mul_f32 v71, v10, v71
    v_mul_f32 v72, v10, v72
    v_mul_f32 v73, v10, v73
    v_mul_f32 v74, v10, v74
    v_mul_f32 v75, v10, v75
    v_mul_f32 v76, v10, v76
    v_mul_f32 v77, v10, v77
    v_mul_f32 v78, v10, v78
    v_mul_f32 v79, v10, v79
    v_mul_f32 v80, v10, v80
    v_mul_f32 v81, v10, v81
    v_mul_f32 v82, v10, v82
    v_mul_f32 v83, v10, v83
    v_mul_f32 v84, v10, v84
    v_mul_f32 v85, v10, v85
    v_mul_f32 v86, v10, v86
    v_mul_f32 v87, v10, v87
    v_mul_f32 v88, v10, v88
    v_mul_f32 v89, v10, v89
    v_mul_f32 v90, v10, v90
    v_mul_f32 v91, v10, v91
    v_mul_f32 v92, v10, v92
    v_mul_f32 v93, v10, v93
    v_mul_f32 v94, v10, v94
    v_mul_f32 v95, v10, v95
    v_mul_f32 v96, v10, v96
    v_mul_f32 v97, v10, v97
    v_mul_f32 v98, v10, v98
    v_mul_f32 v99, v10, v99
    v_mul_f32 v100, v10, v100
    v_mul_f32 v101, v10, v101
    v_mul_f32 v102, v10, v102
    v_mul_f32 v103, v10, v103
    v_mul_f32 v104, v10, v104
    v_mul_f32 v105, v10, v105
    v_mul_f32 v106, v10, v106
    v_mul_f32 v107, v10, v107
    v_mul_f32 v108, v10, v108
    v_mul_f32 v109, v10, v109
    v_mul_f32 v110, v10, v110
    v_mul_f32 v111, v10, v111
    v_mul_f32 v112, v10, v112
    v_mul_f32 v113, v10, v113
    v_mul_f32 v114, v10, v114
    v_mul_f32 v115, v10, v115
    v_mul_f32 v116, v10, v116
    v_mul_f32 v117, v10, v117
    v_mul_f32 v118, v10, v118
    v_mul_f32 v119, v10, v119
    v_mul_f32 v120, v10, v120
    v_mul_f32 v121, v10, v121
    v_mul_f32 v122, v10, v122
    v_mul_f32 v123, v10, v123
    v_mul_f32 v124, v10, v124
    v_mul_f32 v125, v10, v125
    v_mul_f32 v126, v10, v126
    v_mul_f32 v127, v10, v127
    s_nop 4
    s_branch L_rareA_ret
L_rareB:
    v_mov_b32 v3, v11
    s_nop 1
    v_permlane32_swap_b32 v11, v3
    v_max3_f32 v11, v11, v3, s69
    v_sub_f32 v160, v160, v11
    v_sub_f32 v161, v161, v11
    v_sub_f32 v162, v162, v11
    v_sub_f32 v163, v163, v11
    v_sub_f32 v164, v164, v11
    v_sub_f32 v165, v165, v11
    v_sub_f32 v166, v166, v11
    v_sub_f32 v167, v167, v11
    v_sub_f32 v168, v168, v11
    v_sub_f32 v169, v169, v11
    v_sub_f32 v170, v170, v11
    v_sub_f32 v171, v171, v11
    v_sub_f32 v172, v172, v11
    v_sub_f32 v173, v173, v11
    v_sub_f32 v174, v174, v11
    v_sub_f32 v175, v175, v11
    v_sub_f32 v176, v176, v11
    v_sub_f32 v177, v177, v11
    v_sub_f32 v178, v178, v11
    v_sub_f32 v179, v179, v11
    v_sub_f32 v180, v180, v11
    v_sub_f32 v181, v181, v11
    v_sub_f32 v182, v182, v11
    v_sub_f32 v183, v183, v11
    v_sub_f32 v184, v184, v11
    v_sub_f32 v185, v185, v11
    v_sub_f32 v186, v186, v11
    v_sub_f32 v187, v187, v11
    v_sub_f32 v188, v188, v11
    v_sub_f32 v189, v189, v11
    v_sub_f32 v190, v190, v11
    v_sub_f32 v191, v191, v11
    v_sub_f32 v208, v208, v11
    v_sub_f32 v209, v209, v11
    v_sub_f32 v210, v210, v11
    v_sub_f32 v211, v211, v11
    v_sub_f32 v212, v212, v11
    v_sub_f32 v213, v213, v11
    v_sub_f32 v214, v214, v11
    v_sub_f32 v215, v215, v11
    v_sub_f32 v216, v216, v11
    v_sub_f32 v217, v217, v11
    v_sub_f32 v218, v218, v11
    v_sub_f32 v219, v219, v11
    v_sub_f32 v220, v220, v11
    v_sub_f32 v221, v221, v11
    v_sub_f32 v222, v222, v11
    v_sub_f32 v223, v223, v11
    s_cmp_lg_u32 s69, 0
    s_mov_b32 s68, 0x41000000
    s_mov_b32 s69, 0
    s_cbranch_scc1 L_rareB_ret
    v_sub_f32 v10, 0, v11
    v_exp_f32 v10, v10
    s_nop 0
    v_mul_f32 v8, v10, v8
    v_mul_f32 v9, v10, v9
    v_mul_f32 v64, v10, v64
    v_mul_f32 v65, v10, v65
    v_mul_f32 v66, v10, v66
    v_mul_f32 v67, v10, v67
    v_mul_f32 v68, v10, v68
    v_mul_f32 v69, v10, v69
    v_mul_f32 v70, v10, v70
    v_mul_f32 v71, v10, v71
    v_mul_f32 v72, v10, v72
    v_mul_f32 v73, v10, v73
    v_mul_f32 v74, v10, v74
    v_mul_f32 v75, v10, v75
    v_mul_f32 v76, v10, v76
    v_mul_f32 v77, v10, v77
    v_mul_f32 v78, v10, v78
    v_mul_f32 v79, v10, v79
    v_mul_f32 v80, v10, v80
    v_mul_f32 v81, v10, v81
    v_mul_f32 v82, v10, v82
    v_mul_f32 v83, v10, v83
    v_mul_f32 v84, v10, v84
    v_mul_f32 v85, v10, v85
    v_mul_f32 v86, v10, v86
    v_mul_f32 v87, v10, v87
    v_mul_f32 v88, v10, v88
    v_mul_f32 v89, v10, v89
    v_mul_f32 v90, v10, v90
    v_mul_f32 v91, v10, v91
    v_mul_f32 v92, v10, v92
    v_mul_f32 v93, v10, v93
    v_mul_f32 v94, v10, v94
    v_mul_f32 v95, v10, v95
    v_mul_f32 v96, v10, v96
    v_mul_f32 v97, v10, v97
    v_mul_f32 v98, v10, v98
    v_mul_f32 v99, v10, v99
    v_mul_f32 v100, v10, v100
    v_mul_f32 v101, v10, v101
    v_mul_f32 v102, v10, v102
    v_mul_f32 v103, v10, v103
    v_mul_f32 v104, v10, v104
    v_mul_f32 v105, v10, v105
    v_mul_f32 v106, v10, v106
    v_mul_f32 v107, v10, v107
    v_mul_f32 v108, v10, v108
    v_mul_f32 v109, v10, v109
    v_mul_f32 v110, v10, v110
    v_mul_f32 v111, v10, v111
    v_mul_f32 v112, v10, v112
    v_mul_f32 v113, v10, v113
    v_mul_f32 v114, v10, v114
    v_mul_f32 v115, v10, v115
    v_mul_f32 v116, v10, v116
    v_mul_f32 v117, v10, v117
    v_mul_f32 v118, v10, v118
    v_mul_f32 v119, v10, v119
    v_mul_f32 v120, v10, v120
    v_mul_f32 v121, v10, v121
    v_mul_f32 v122, v10, v122
    v_mul_f32 v123, v10, v123
    v_mul_f32 v124, v10, v124
    v_mul_f32 v125, v10, v125
    v_mul_f32 v126, v10, v126
    v_mul_f32 v127, v10, v127
    s_nop 4
    s_branch L_rareB_ret
L_epi:
    v_add_f32 v8, v8, v9
    v_mov_b32 v3, v8
    s_nop 1
    v_permlane32_swap_b32 v8, v3
    v_add_f32 v8, v8, v3
    v_rcp_f32 v8, v8
    s_cmp_eq_u32 s45, 8
    s_cbranch_scc1 L_A_end
    v_mul_f32 v64, v8, v64
    v_mul_f32 v65, v8, v65
    v_mul_f32 v66, v8, v66
    v_mul_f32 v67, v8, v67
    v_mul_f32 v68, v8, v68
    v_mul_f32 v69, v8, v69
    v_mul_f32 v70, v8, v70
    v_mul_f32 v71, v8, v71
    v_cvt_pk_bf16_f32 v160, v64, v65
    v_cvt_pk_bf16_f32 v161, v66, v67
    v_cvt_pk_bf16_f32 v162, v68, v69
    v_cvt_pk_bf16_f32 v163, v70, v71
    ds_write_b128 v14, v[160:163] offset:0
    v_mul_f32 v72, v8, v72
    v_mul_f32 v73, v8, v73
    v_mul_f32 v74, v8, v74
    v_mul_f32 v75, v8, v75
    v_mul_f32 v76, v8, v76
    v_mul_f32 v77, v8, v77
    v_mul_f32 v78, v8, v78
    v_mul_f32 v79, v8, v79
    v_cvt_pk_bf16_f32 v164, v72, v73
    v_cvt_pk_bf16_f32 v165, v74, v75
    v_cvt_pk_bf16_f32 v166, v76, v77
    v_cvt_pk_bf16_f32 v167, v78, v79
    ds_write_b128 v14, v[164:167] offset:1024
    v_mul_f32 v80, v8, v80
    v_mul_f32 v81, v8, v81
    v_mul_f32 v82, v8, v82
    v_mul_f32 v83, v8, v83
    v_mul_f32 v84, v8, v84
    v_mul_f32 v85, v8, v85
    v_mul_f32 v86, v8, v86
    v_mul_f32 v87, v8, v87
    v_cvt_pk_bf16_f32 v168, v80, v81
    v_cvt_pk_bf16_f32 v169, v82, v83
    v_cvt_pk_bf16_f32 v170, v84, v85
    v_cvt_pk_bf16_f32 v171, v86, v87
    ds_write_b128 v14, v[168:171] offset:2048
    v_mul_f32 v88, v8, v88
    v_mul_f32 v89, v8, v89
    v_mul_f32 v90, v8, v90
    v_mul_f32 v91, v8, v91
    v_mul_f32 v92, v8, v92
    v_mul_f32 v93, v8, v93
    v_mul_f32 v94, v8, v94
    v_mul_f32 v95, v8, v95
    v_cvt_pk_bf16_f32 v172, v88, v89
    v_cvt_pk_bf16_f32 v173, v90, v91
    v_cvt_pk_bf16_f32 v174, v92, v93
    v_cvt_pk_bf16_f32 v175, v94, v95
    ds_write_b128 v14, v[172:175] offset:3072
    v_mul_f32 v96, v8, v96
    v_mul_f32 v97, v8, v97
    v_mul_f32 v98, v8, v98
    v_mul_f32 v99, v8, v99
    v_mul_f32 v100, v8, v100
    v_mul_f32 v101, v8, v101
    v_mul_f32 v102, v8, v102
    v_mul_f32 v103, v8, v103
    v_cvt_pk_bf16_f32 v176, v96, v97
    v_cvt_pk_bf16_f32 v177, v98, v99
    v_cvt_pk_bf16_f32 v178, v100, v101
    v_cvt_pk_bf16_f32 v179, v102, v103
    ds_write_b128 v14, v[176:179] offset:4096
    v_mul_f32 v104, v8, v104
    v_mul_f32 v105, v8, v105
    v_mul_f32 v106, v8, v106
    v_mul_f32 v107, v8, v107
    v_mul_f32 v108, v8, v108
    v_mul_f32 v109, v8, v109
    v_mul_f32 v110, v8, v110
    v_mul_f32 v111, v8, v111
    v_cvt_pk_bf16_f32 v180, v104, v105
    v_cvt_pk_bf16_f32 v181, v106, v107
    v_cvt_pk_bf16_f32 v182, v108, v109
    v_cvt_pk_bf16_f32 v183, v110, v111
    ds_write_b128 v14, v[180:183] offset:5120
    v_mul_f32 v112, v8, v112
    v_mul_f32 v113, v8, v113
    v_mul_f32 v114, v8, v114
    v_mul_f32 v115, v8, v115
    v_mul_f32 v116, v8, v116
    v_mul_f32 v117, v8, v117
    v_mul_f32 v118, v8, v118
    v_mul_f32 v119, v8, v119
    v_cvt_pk_bf16_f32 v184, v112, v113
    v_cvt_pk_bf16_f32 v185, v114, v115
    v_cvt_pk_bf16_f32 v186, v116, v117
    v_cvt_pk_bf16_f32 v187, v118, v119
    ds_write_b128 v14, v[184:187] offset:6144
    v_mul_f32 v120, v8, v120
    v_mul_f32 v121, v8, v121
    v_mul_f32 v122, v8, v122
    v_mul_f32 v123, v8, v123
    v_mul_f32 v124, v8, v124
    v_mul_f32 v125, v8, v125
    v_mul_f32 v126, v8, v126
    v_mul_f32 v127, v8, v127
    v_cvt_pk_bf16_f32 v188, v120, v121
    v_cvt_pk_bf16_f32 v189, v122, v123
    v_cvt_pk_bf16_f32 v190, v124, v125
    v_cvt_pk_bf16_f32 v191, v126, v127
    ds_write_b128 v14, v[188:191] offset:7168
    s_cmp_lt_u32 s36, 2
    s_mov_b32 s41, 0x0
    s_cselect_b32 s41, 0xffff4000, s41
    v_mov_b32 v64, 0
    v_mov_b32 v65, 0
    v_mov_b32 v66, 0
    v_mov_b32 v67, 0
    v_mov_b32 v68, 0
    v_mov_b32 v69, 0
    v_mov_b32 v70, 0
    v_mov_b32 v71, 0
    v_mov_b32 v72, 0
    v_mov_b32 v73, 0
    v_mov_b32 v74, 0
    v_mov_b32 v75, 0
    v_mov_b32 v76, 0
    v_mov_b32 v77, 0
    v_mov_b32 v78, 0
    v_mov_b32 v79, 0
    v_mov_b32 v80, 0
    v_mov_b32 v81, 0
    v_mov_b32 v82, 0
    v_mov_b32 v83, 0
    v_mov_b32 v84, 0
    v_mov_b32 v85, 0
    v_mov_b32 v86, 0
    v_mov_b32 v87, 0
    v_mov_b32 v88, 0
    v_mov_b32 v89, 0
    v_mov_b32 v90, 0
    v_mov_b32 v91, 0
    v_mov_b32 v92, 0
    v_mov_b32 v93, 0
    v_mov_b32 v94, 0
    v_mov_b32 v95, 0
    v_mov_b32 v96, 0
    v_mov_b32 v97, 0
    v_mov_b32 v98, 0
    v_mov_b32 v99, 0
    v_mov_b32 v100, 0
    v_mov_b32 v101, 0
    v_mov_b32 v102, 0
    v_mov_b32 v103, 0
    v_mov_b32 v104, 0
    v_mov_b32 v105, 0
    v_mov_b32 v106, 0
    v_mov_b32 v107, 0
    v_mov_b32 v108, 0
    v_mov_b32 v109, 0
    v_mov_b32 v110, 0
    v_mov_b32 v111, 0
    v_mov_b32 v112, 0
    v_mov_b32 v113, 0
    v_mov_b32 v114, 0
    v_mov_b32 v115, 0
    v_mov_b32 v116, 0
    v_mov_b32 v117, 0
    v_mov_b32 v118, 0
    v_mov_b32 v119, 0
    v_mov_b32 v120, 0
    v_mov_b32 v121, 0
    v_mov_b32 v122, 0
    v_mov_b32 v123, 0
    v_mov_b32 v124, 0
    v_mov_b32 v125, 0
    v_mov_b32 v126, 0
    v_mov_b32 v127, 0
    v_add_u32 v14, s41, v14
    v_mov_b32 v8, 0
    v_mov_b32 v9, 0
    s_mov_b32 s68, 0xff800000
    s_mov_b32 s69, 0xff800000
    s_cmp_lg_u32 s74, 0
    s_cbranch_scc1 L_nA
    s_mov_b32 s42, 0
L_ng:
    s_waitcnt vmcnt(0)
    v_readfirstlane_b32 s98, v12
    s_nop 1
    s_cmp_lg_u32 s98, 0
    s_cbranch_scc1 L_ng_ok
    s_add_u32 s42, s42, 1
    s_cmp_gt_u32 s42, 0x40000
    s_cbranch_scc1 L_ng_ok
    s_lshl_b32 s41, s37, 2
    buffer_load_dword v12, v6, s[88:91], s41 offen sc1
    s_branch L_ng
L_ng_ok:
    v_mov_b32 v2, 0x24000
    s_waitcnt vmcnt(0)
    ds_write_b32 v2, v12
    s_nop 2
L_nA:
    s_waitcnt lgkmcnt(0)
    s_branch L_chkA
L_A_end:
    s_add_u32 s41, s49, 4096
    v_mul_f32 v64, v8, v64
    v_mul_f32 v65, v8, v65
    v_mul_f32 v66, v8, v66
    v_mul_f32 v67, v8, v67
    v_mul_f32 v68, v8, v68
    v_mul_f32 v69, v8, v69
    v_mul_f32 v70, v8, v70
    v_mul_f32 v71, v8, v71
    v_cvt_pk_bf16_f32 v160, v64, v65
    v_cvt_pk_bf16_f32 v161, v66, v67
    v_cvt_pk_bf16_f32 v162, v68, v69
    v_cvt_pk_bf16_f32 v163, v70, v71
    buffer_store_dwordx4 v[160:163], v7, s[24:27], s49 offen offset:0 sc1
    v_mul_f32 v72, v8, v72
    v_mul_f32 v73, v8, v73
    v_mul_f32 v74, v8, v74
    v_mul_f32 v75, v8, v75
    v_mul_f32 v76, v8, v76
    v_mul_f32 v77, v8, v77
    v_mul_f32 v78, v8, v78
    v_mul_f32 v79, v8, v79
    v_cvt_pk_bf16_f32 v164, v72, v73
    v_cvt_pk_bf16_f32 v165, v74, v75
    v_cvt_pk_bf16_f32 v166, v76, v77
    v_cvt_pk_bf16_f32 v167, v78, v79
    buffer_store_dwordx4 v[164:167], v7, s[24:27], s49 offen offset:1024 sc1
    v_mul_f32 v80, v8, v80
    v_mul_f32 v81, v8, v81
    v_mul_f32 v82, v8, v82
    v_mul_f32 v83, v8, v83
    v_mul_f32 v84, v8, v84
    v_mul_f32 v85, v8, v85
    v_mul_f32 v86, v8, v86
    v_mul_f32 v87, v8, v87
    v_cvt_pk_bf16_f32 v168, v80, v81
    v_cvt_pk_bf16_f32 v169, v82, v83
    v_cvt_pk_bf16_f32 v170, v84, v85
    v_cvt_pk_bf16_f32 v171, v86, v87
    buffer_store_dwordx4 v[168:171], v7, s[24:27], s49 offen offset:2048 sc1
    v_mul_f32 v88, v8, v88
    v_mul_f32 v89, v8, v89
    v_mul_f32 v90, v8, v90
    v_mul_f32 v91, v8, v91
    v_mul_f32 v92, v8, v92
    v_mul_f32 v93, v8, v93
    v_mul_f32 v94, v8, v94
    v_mul_f32 v95, v8, v95
    v_cvt_pk_bf16_f32 v172, v88, v89
    v_cvt_pk_bf16_f32 v173, v90, v91
    v_cvt_pk_bf16_f32 v174, v92, v93
    v_cvt_pk_bf16_f32 v175, v94, v95
    buffer_store_dwordx4 v[172:175], v7, s[24:27], s49 offen offset:3072 sc1
    v_mul_f32 v96, v8, v96
    v_mul_f32 v97, v8, v97
    v_mul_f32 v98, v8, v98
    v_mul_f32 v99, v8, v99
    v_mul_f32 v100, v8, v100
    v_mul_f32 v101, v8, v101
    v_mul_f32 v102, v8, v102
    v_mul_f32 v103, v8, v103
    v_cvt_pk_bf16_f32 v176, v96, v97
    v_cvt_pk_bf16_f32 v177, v98, v99
    v_cvt_pk_bf16_f32 v178, v100, v101
    v_cvt_pk_bf16_f32 v179, v102, v103
    buffer_store_dwordx4 v[176:179], v7, s[24:27], s41 offen offset:0 sc1
    v_mul_f32 v104, v8, v104
    v_mul_f32 v105, v8, v105
    v_mul_f32 v106, v8, v106
    v_mul_f32 v107, v8, v107
    v_mul_f32 v108, v8, v108
    v_mul_f32 v109, v8, v109
    v_mul_f32 v110, v8, v110
    v_mul_f32 v111, v8, v111
    v_cvt_pk_bf16_f32 v180, v104, v105
    v_cvt_pk_bf16_f32 v181, v106, v107
    v_cvt_pk_bf16_f32 v182, v108, v109
    v_cvt_pk_bf16_f32 v183, v110, v111
    buffer_store_dwordx4 v[180:183], v7, s[24:27], s41 offen offset:1024 sc1
    v_mul_f32 v112, v8, v112
    v_mul_f32 v113, v8, v113
    v_mul_f32 v114, v8, v114
    v_mul_f32 v115, v8, v115
    v_mul_f32 v116, v8, v116
    v_mul_f32 v117, v8, v117
    v_mul_f32 v118, v8, v118
    v_mul_f32 v119, v8, v119
    v_cvt_pk_bf16_f32 v184, v112, v113
    v_cvt_pk_bf16_f32 v185, v114, v115
    v_cvt_pk_bf16_f32 v186, v116, v117
    v_cvt_pk_bf16_f32 v187, v118, v119
    buffer_store_dwordx4 v[184:187], v7, s[24:27], s41 offen offset:2048 sc1
    v_mul_f32 v120, v8, v120
    v_mul_f32 v121, v8, v121
    v_mul_f32 v122, v8, v122
    v_mul_f32 v123, v8, v123
    v_mul_f32 v124, v8, v124
    v_mul_f32 v125, v8, v125
    v_mul_f32 v126, v8, v126
    v_mul_f32 v127, v8, v127
    v_cvt_pk_bf16_f32 v188, v120, v121
    v_cvt_pk_bf16_f32 v189, v122, v123
    v_cvt_pk_bf16_f32 v190, v124, v125
    v_cvt_pk_bf16_f32 v191, v126, v127
    buffer_store_dwordx4 v[188:191], v7, s[24:27], s41 offen offset:3072 sc1
    ds_write_b128 v14, v[160:163] offset:0
    ds_write_b128 v14, v[164:167] offset:1024
    ds_write_b128 v14, v[168:171] offset:2048
    ds_write_b128 v14, v[172:175] offset:3072
    ds_write_b128 v14, v[176:179] offset:4096
    ds_write_b128 v14, v[180:183] offset:5120
    ds_write_b128 v14, v[184:187] offset:6144
    ds_write_b128 v14, v[188:191] offset:7168
    s_waitcnt vmcnt(0) lgkmcnt(0)
    v_mov_b32 v2, s98
    s_lshl_b32 s41, s87, 2
    s_add_u32 s41, s41, s84
    s_mov_b64 exec, 1
    buffer_store_dword v2, v6, s[24:27], s41 offen sc1
    s_mov_b64 exec, -1
    s_barrier
    buffer_load_dwordx4 v[24:27], v6, s[24:27], s84 offen sc1
    s_waitcnt vmcnt(0)
    s_mov_b32 s43, 0
L_pc1:
    v_xor_b32 v24, s98, v24
    v_xor_b32 v25, s98, v25
    v_xor_b32 v26, s98, v26
    v_xor_b32 v27, s98, v27
    v_or3_b32 v24, v24, v25, v26
    v_or_b32 v24, v24, v27
    s_nop 0
    v_readfirstlane_b32 s41, v24
    s_nop 1
    s_cmp_eq_u32 s41, 0
    s_cbranch_scc1 L_ok1
    s_add_u32 s43, s43, 1
    s_cmp_gt_u32 s43, 0x40000
    s_cbranch_scc1 L_ok1
    buffer_load_dwordx4 v[24:27], v6, s[24:27], s84 offen sc1
    s_waitcnt vmcnt(0)
    s_branch L_pc1
L_ok1:
    s_barrier
    s_cmp_lg_u32 s74, 0
    s_cbranch_scc1 L_fin
    s_barrier
    s_barrier
    v_mov_b32 v2, s98
    s_lshl_b32 s41, s85, 2
    s_add_u32 s41, s41, s99
    s_mov_b64 exec, 1
    buffer_store_dword v2, v6, s[24:27], s41 offen sc1
    s_mov_b64 exec, -1
    buffer_load_dwordx4 v[24:27], v6, s[24:27], s99 offen sc1
    s_waitcnt vmcnt(0)
    s_mov_b32 s43, 0
L_pc2:
    v_xor_b32 v24, s98, v24
    v_xor_b32 v25, s98, v25
    v_xor_b32 v26, s98, v26
    v_xor_b32 v27, s98, v27
    v_or3_b32 v24, v24, v25, v26
    v_or_b32 v24, v24, v27
    s_nop 0
    v_readfirstlane_b32 s41, v24
    s_nop 1
    s_cmp_eq_u32 s41, 0
    s_cbranch_scc1 L_ok2
    s_add_u32 s43, s43, 1
    s_cmp_gt_u32 s43, 0x40000
    s_cbranch_scc1 L_ok2
    buffer_load_dwordx4 v[24:27], v6, s[24:27], s99 offen sc1
    s_waitcnt vmcnt(0)
    s_branch L_pc2
L_ok2:
    s_barrier
L_fin:
L_done:
    s_endpgm
L_end:
.section .rodata,"a"
.p2align 6
.amdhsa_kernel standalone__mha_block_cached__near_ridge_kernel
  .amdhsa_next_free_vgpr 256
  .amdhsa_next_free_sgpr 100
  .amdhsa_accum_offset 256
  .amdhsa_group_segment_fixed_size 0
  .amdhsa_kernarg_size 64
  .amdhsa_user_sgpr_count 2
  .amdhsa_user_sgpr_kernarg_segment_ptr 1
  .amdhsa_system_sgpr_workgroup_id_x 1
.end_amdhsa_kernel
```
